```python
import torch

def _softmax(x, axis=-1):
    return torch.softmax(x, dim=axis)
def _gelu(x):
    return torch.nn.functional.gelu(x, approximate="tanh")
def _silu(x):
    return torch.nn.functional.silu(x)
def _sigmoid(x):
    return torch.sigmoid(x)
def _layernorm(x, axis=-1, eps=1e-5):
    m = x.mean(dim=axis, keepdim=True)
    v = x.var(dim=axis, keepdim=True, unbiased=False)
    return (x - m) / torch.sqrt(v + eps)
def _scatter_add(tgt, idx, src, axis=0):
    return tgt.clone().index_add_(axis, idx, src)
def _segment_sum(src, seg, n):
    out = torch.zeros((n,) + src.shape[1:], dtype=src.dtype)
    return out.index_add_(0, seg, src)
def _pad(x, pw):
    flat = tuple(v for pair in reversed(pw) for v in pair)
    return torch.nn.functional.pad(x, flat)

kernel_name = 'concat_heads__sliding_block__mha_block__prompt'

def setup_inputs():

    _w = (lambda a: (lambda t: t.to(torch.bfloat16) if t.is_floating_point() else t)(torch.as_tensor(a)))
    def _A_setup():
        B, S, D = 1, 2048, 640
        return {
            "x": _w((lambda *s: torch.randn(*s, dtype=torch.bfloat16) * 0.4)(B, S, D)),
            "wqkv": _w((lambda *s: torch.randn(*s, dtype=torch.bfloat16) * 0.4)(D, 3 * D)),
            "wo": _w((lambda *s: torch.randn(*s, dtype=torch.bfloat16) * 0.05)(D, D)),
        }
    _A_in = _A_setup()

    def _B_setup():
        B, S, D, H = 1, 2048, 640, 32
        return {
            "x": _w((lambda *s: torch.randn(*s, dtype=torch.bfloat16) * 0.2)(B, S, D)),
            "wqkv": _w((lambda *s: torch.randn(*s, dtype=torch.bfloat16) * 0.4)(D, 3 * D)),
            "wo": _w((lambda *s: torch.randn(*s, dtype=torch.bfloat16) * 0.1)(D, D)),
        }
    _B_in = _B_setup()

    return {
        "A_x": _A_in["x"],
        "A_wqkv": _A_in["wqkv"],
        "A_wo": _A_in["wo"],
        "B_x": _B_in["x"],
        "B_wqkv": _B_in["wqkv"],
        "B_wo": _B_in["wo"],
    }

def reference(A_x, A_wqkv, A_wo, B_x, B_wqkv, B_wo):
    def _A_ref(x, wqkv, wo):
        B, S, D = x.shape
        H = 32; Dh = D // H; W = 256
        qkv = (lambda x, *d: x.permute(*d))((x @ wqkv).reshape(B, S, 3, H, Dh), 2, 0, 3, 1, 4)
        q, k, v = qkv[0], qkv[1], qkv[2]
        scores = torch.einsum("bhqd,bhkd->bhqk", q, k) * (Dh ** -0.5)
        idx = torch.arange(S)
        mask = (idx[:, None] - idx[None, :] >= 0) & (idx[:, None] - idx[None, :] < W)
        scores = torch.where(mask[None, None], scores, -1e9)
        p = _softmax(scores, axis=-1)
        o = torch.einsum("bhqk,bhkd->bhqd", p, v)
        return (lambda x, *d: x.permute(*d))(o, 0, 2, 1, 3).reshape(B, S, D) @ wo

    def _B_ref(x, wqkv, wo):
        B, S, D = x.shape
        H = 32
        Dh = D // H
        qkv = (lambda x, *d: x.permute(*d))((x @ wqkv).reshape(B, S, 3, H, Dh), 2, 0, 3, 1, 4)
        q, k, v = qkv[0], qkv[1], qkv[2]
        scores = torch.einsum("bhqd,bhkd->bhqk", q, k) * (Dh ** -0.5)
        p = _softmax(scores, axis=-1)
        o = torch.einsum("bhqk,bhkd->bhqd", p, v)
        return (lambda x, *d: x.permute(*d))(o, 0, 2, 1, 3).reshape(B, S, D) @ wo

    a = _A_ref(A_x, A_wqkv, A_wo)
    b = _B_ref(B_x, B_wqkv, B_wo)
    return torch.concatenate([a, b], axis=-1)
```

```asm
; @launch grid=(256,1,1) block=(512,1,1) lds=163840
.amdgcn_target "amdgcn-amd-amdhsa--gfx950"
.text
.globl concat_heads__sliding_block__mha_block__prompt_kernel
.p2align 8
.type concat_heads__sliding_block__mha_block__prompt_kernel,@function
concat_heads__sliding_block__mha_block__prompt_kernel:
  s_cmp_ge_u32 s2, 256
  s_cbranch_scc1 L_exit
  s_load_dwordx2 s[98:99], s[0:1], 56
  s_load_dwordx2 s[100:101], s[0:1], 64
  s_load_dwordx4 s[16:19], s[0:1], 0
  s_load_dwordx4 s[20:23], s[0:1], 24
  s_mov_b32 s96, s2
  v_lshrrev_b32 v2, 6, v0
  s_nop 0
  v_readfirstlane_b32 s97, v2
  s_cmp_lg_u32 s96, 0
  s_cbranch_scc1 L_notok
  s_cmp_lg_u32 s97, 4
  s_cbranch_scc1 L_notok
  s_memrealtime s[56:57]
  s_waitcnt lgkmcnt(0)
  s_or_b32 s56, s56, 1
  s_mov_b64 exec, 1
  v_mov_b32 v2, 0
  v_mov_b32 v3, s56
  global_store_dword v2, v3, s[98:99] sc1
  s_mov_b64 exec, -1
L_notok:
  s_cmp_lg_u32 s97, 5
  s_cbranch_scc1 L_nocpf
  s_getpc_b64 s[56:57]
L_pc:
  s_lshr_b32 s58, s96, 3
  s_and_b32 s58, s58, 31
  s_lshl_b32 s58, s58, 10
  v_and_b32 v2, 63, v0
  v_lshlrev_b32 v2, 4, v2
  v_add_u32 v2, s58, v2
  v_min_u32 v2, CODE_BYTES-16, v2
  global_load_dwordx4 v[84:87], v2, s[56:57]
L_nocpf:
  v_and_b32 v1, 63, v0
  s_and_b32 s41, s96, 7
  s_lshr_b32 s42, s96, 3
  s_and_b32 s43, s41, 1
  s_lshl_b32 s43, s43, 3
  s_and_b32 s44, s42, 7
  s_add_u32 s27, s43, s44
  s_lshr_b32 s43, s41, 1
  s_lshl_b32 s43, s43, 2
  s_lshr_b32 s42, s42, 3
  s_add_u32 s28, s43, s42
  s_cmp_ge_u32 s28, 15
  s_cbranch_scc1 L_p1_skip
  s_cmp_ge_u32 s97, 4
  s_cbranch_scc0 L_p1_compute
L_p1_loader:
  s_setprio 2
  s_sub_u32 s29, s97, 4
  s_mul_i32 s44, s44, 5
  s_lshr_b32 s44, s44, 2
  s_mul_i32 s42, s42, 5
  s_lshr_b32 s42, s42, 1
  s_add_u32 s31, s44, s42
  s_and_b32 s41, s96, 7
  s_lshr_b32 s42, s41, 1
  s_mul_i32 s42, s42, 2
  s_add_u32 s31, s31, s42
  s_and_b32 s41, s41, 1
  s_mul_i32 s41, s41, 1
  s_add_u32 s31, s31, s41
  s_cmp_ge_u32 s31, 40
  s_cselect_b32 s41, 20, 0
  s_sub_u32 s31, s31, s41
  s_cmp_ge_u32 s31, 20
  s_cselect_b32 s41, 10, 0
  s_sub_u32 s31, s31, s41
  s_cmp_ge_u32 s31, 20
  s_cselect_b32 s41, 10, 0
  s_sub_u32 s31, s31, s41
  s_cmp_ge_u32 s31, 10
  s_cselect_b32 s41, 10, 0
  s_sub_u32 s31, s31, s41
  s_mov_b32 s30, s31
  s_lshl_b32 s38, s29, 12
  s_lshl_b32 s39, s29, 12
  s_add_u32 s39, s39, 16384
  v_lshrrev_b32 v6, 4, v1
  v_bfe_u32 v7, v1, 1, 3
  v_and_b32 v2, 1, v1
  s_lshl_b32 s43, s29, 4
  s_lshl_b32 s42, s28, 8
  v_add_u32 v3, 0, v6
  v_xor_b32 v3, v3, v7
  v_lshl_add_u32 v4, v3, 1, v2
  v_lshlrev_b32 v4, 4, v4
  v_add_u32 v8, s43, v6
  v_mul_u32_u24 v8, 3840, v8
  v_add3_u32 v8, v8, v4, s42
  v_add_u32 v3, 4, v6
  v_xor_b32 v3, v3, v7
  v_lshl_add_u32 v4, v3, 1, v2
  v_lshlrev_b32 v4, 4, v4
  v_add_u32 v9, s43, v6
  v_add_u32 v9, 8, v9
  v_mul_u32_u24 v9, 3840, v9
  v_add3_u32 v9, v9, v4, s42
  v_lshrrev_b32 v6, 3, v1
  v_and_b32 v7, 7, v1
  s_lshl_b32 s41, s27, 7
  s_lshl_b32 s42, s29, 5
  s_add_u32 s41, s41, s42
  v_lshrrev_b32 v2, 1, v6
  v_xor_b32 v2, v2, v7
  v_add_u32 v3, s41, v6
  v_mul_u32_u24 v3, 1280, v3
  v_lshl_add_u32 v10, v2, 4, v3
  v_lshrrev_b32 v2, 1, v6
  v_add_u32 v2, 4, v2
  v_xor_b32 v2, v2, v7
  v_add_u32 v3, s41, v6
  v_add_u32 v3, 8, v3
  v_mul_u32_u24 v3, 1280, v3
  v_lshl_add_u32 v11, v2, 4, v3
  s_waitcnt lgkmcnt(0)
  s_mov_b32 s4, s20
  s_and_b32 s5, s21, 0xffff
  s_mov_b32 s6, 2621440
  s_mov_b32 s7, 0x20000
  s_mov_b32 s8, s22
  s_and_b32 s9, s23, 0xffff
  s_mov_b32 s10, 2457600
  s_mov_b32 s11, 0x20000
  s_mov_b32 s35, 0
  s_mul_i32 s34, s31, 245760
  s_lshl_b32 s32, s31, 7
  s_lshl_b32 s37, s35, 15
  s_lshr_b32 s44, s35, 1
  s_lshl_b32 s44, s44, 14
  s_add_u32 s37, s37, s44
  s_add_u32 s37, s37, 16384
  s_add_u32 s41, s37, s38
  s_add_u32 s42, s37, s39
  s_add_u32 m0, s41, 0
  s_nop 0
  buffer_load_dwordx4 v8, s[8:11], s34 offen  lds
  s_add_u32 m0, s42, 0
  s_nop 0
  buffer_load_dwordx4 v10, s[4:7], s32 offen  lds
  s_add_u32 m0, s41, 1024
  s_add_u32 s43, s34, 15360
  buffer_load_dwordx4 v8, s[8:11], s43 offen  lds
  s_add_u32 m0, s42, 1024
  s_nop 0
  buffer_load_dwordx4 v11, s[4:7], s32 offen  lds
  s_add_u32 m0, s41, 2048
  s_nop 0
  buffer_load_dwordx4 v9, s[8:11], s34 offen  lds
  s_add_u32 m0, s42, 2048
  s_add_u32 s32, s32, 20480
  buffer_load_dwordx4 v10, s[4:7], s32 offen  lds
  s_add_u32 m0, s41, 3072
  s_add_u32 s43, s34, 15360
  buffer_load_dwordx4 v9, s[8:11], s43 offen  lds
  s_add_u32 m0, s42, 3072
  s_nop 0
  buffer_load_dwordx4 v11, s[4:7], s32 offen  lds
  s_add_u32 s31, s31, 1
  s_cmp_eq_u32 s31, 10
  s_cselect_b32 s31, 0, s31
  s_add_u32 s35, s35, 1
  s_and_b32 s35, s35, 3
  s_waitcnt vmcnt(0)
  s_barrier
  s_mul_i32 s34, s31, 245760
  s_lshl_b32 s32, s31, 7
  s_lshl_b32 s37, s35, 15
  s_lshr_b32 s44, s35, 1
  s_lshl_b32 s44, s44, 14
  s_add_u32 s37, s37, s44
  s_add_u32 s37, s37, 16384
  s_add_u32 s41, s37, s38
  s_add_u32 s42, s37, s39
  s_add_u32 m0, s41, 0
  s_nop 0
  buffer_load_dwordx4 v8, s[8:11], s34 offen  lds
  s_add_u32 m0, s42, 0
  s_nop 0
  buffer_load_dwordx4 v10, s[4:7], s32 offen  lds
  s_add_u32 m0, s41, 1024
  s_add_u32 s43, s34, 15360
  buffer_load_dwordx4 v8, s[8:11], s43 offen  lds
  s_add_u32 m0, s42, 1024
  s_nop 0
  buffer_load_dwordx4 v11, s[4:7], s32 offen  lds
  s_add_u32 m0, s41, 2048
  s_nop 0
  buffer_load_dwordx4 v9, s[8:11], s34 offen  lds
  s_add_u32 m0, s42, 2048
  s_add_u32 s32, s32, 20480
  buffer_load_dwordx4 v10, s[4:7], s32 offen  lds
  s_add_u32 m0, s41, 3072
  s_add_u32 s43, s34, 15360
  buffer_load_dwordx4 v9, s[8:11], s43 offen  lds
  s_add_u32 m0, s42, 3072
  s_nop 0
  buffer_load_dwordx4 v11, s[4:7], s32 offen  lds
  s_add_u32 s31, s31, 1
  s_cmp_eq_u32 s31, 10
  s_cselect_b32 s31, 0, s31
  s_add_u32 s35, s35, 1
  s_and_b32 s35, s35, 3
  s_mul_i32 s34, s31, 245760
  s_lshl_b32 s32, s31, 7
  s_lshl_b32 s37, s35, 15
  s_lshr_b32 s44, s35, 1
  s_lshl_b32 s44, s44, 14
  s_add_u32 s37, s37, s44
  s_add_u32 s37, s37, 16384
  s_add_u32 s41, s37, s38
  s_add_u32 s42, s37, s39
  s_add_u32 m0, s41, 0
  s_nop 0
  buffer_load_dwordx4 v8, s[8:11], s34 offen  lds
  s_add_u32 m0, s42, 0
  s_nop 0
  buffer_load_dwordx4 v10, s[4:7], s32 offen  lds
  s_add_u32 m0, s41, 1024
  s_add_u32 s43, s34, 15360
  buffer_load_dwordx4 v8, s[8:11], s43 offen  lds
  s_add_u32 m0, s42, 1024
  s_nop 0
  buffer_load_dwordx4 v11, s[4:7], s32 offen  lds
  s_add_u32 m0, s41, 2048
  s_nop 0
  buffer_load_dwordx4 v9, s[8:11], s34 offen  lds
  s_add_u32 m0, s42, 2048
  s_add_u32 s32, s32, 20480
  buffer_load_dwordx4 v10, s[4:7], s32 offen  lds
  s_add_u32 m0, s41, 3072
  s_add_u32 s43, s34, 15360
  buffer_load_dwordx4 v9, s[8:11], s43 offen  lds
  s_add_u32 m0, s42, 3072
  s_nop 0
  buffer_load_dwordx4 v11, s[4:7], s32 offen  lds
  s_add_u32 s31, s31, 1
  s_cmp_eq_u32 s31, 10
  s_cselect_b32 s31, 0, s31
  s_add_u32 s35, s35, 1
  s_and_b32 s35, s35, 3
  s_and_b32 s52, s96, 7
  s_lshr_b32 s53, s96, 3
  s_lshl_b32 s50, s52, 2
  s_lshr_b32 s52, s53, 3
  s_add_u32 s50, s50, s52
  s_and_b32 s51, s53, 7
  v_lshlrev_b32 v248, 4, v1
  v_and_b32 v249, 31, v1
  v_lshlrev_b32 v3, 3, v249
  v_add_u32 v245, 1024, v3
  v_mov_b32 v4, 0x70000000
  v_cmp_gt_u32 s[56:57], 32, v1
  s_nop 1
  v_cndmask_b32 v253, v4, v245, s[56:57]
  v_lshrrev_b32 v2, 5, v1
  v_lshlrev_b32 v244, 3, v249
  v_lshl_add_u32 v244, v2, 8, v244
  v_mov_b32 v252, v244
  v_bfe_u32 v3, v249, 2, 2
  v_xor_b32 v3, v3, v2
  v_lshlrev_b32 v3, 4, v3
  v_lshl_add_u32 v246, v249, 6, v3
  v_add_u32 v246, 1280, v246
  v_xor_b32 v247, 32, v246
  v_and_b32 v3, 1, v249
  v_lshlrev_b32 v255, 4, v3
  v_lshrrev_b32 v3, 4, v249
  v_lshl_or_b32 v255, v3, 3, v255
  v_and_b32 v3, 4, v249
  v_or_b32 v255, v255, v3
  v_bfe_u32 v3, v249, 3, 1
  v_lshl_or_b32 v255, v3, 1, v255
  v_bfe_u32 v3, v249, 1, 1
  v_or_b32 v255, v255, v3
  v_lshlrev_b32 v5, 2, v2
  v_sub_u32 v5, v255, v5
  v_mov_b32 v4, 0xf149f2ca
  v_cmp_gt_i32 s[52:53], 0, v5
  s_nop 0
  v_cmp_gt_i32 s[54:55], 16, v5
  s_nop 1
  v_cndmask_b32 v212, v4, 0, s[52:53]
  v_cndmask_b32 v228, 0, v4, s[52:53]
  v_cmp_gt_i32 s[52:53], 1, v5
  v_cndmask_b32 v213, v4, 0, s[54:55]
  v_cndmask_b32 v229, 0, v4, s[54:55]
  v_cmp_gt_i32 s[54:55], 17, v5
  v_cndmask_b32 v214, v4, 0, s[52:53]
  v_cndmask_b32 v230, 0, v4, s[52:53]
  v_cmp_gt_i32 s[52:53], 2, v5
  v_cndmask_b32 v215, v4, 0, s[54:55]
  v_cndmask_b32 v231, 0, v4, s[54:55]
  v_cmp_gt_i32 s[54:55], 18, v5
  v_cndmask_b32 v216, v4, 0, s[52:53]
  v_cndmask_b32 v232, 0, v4, s[52:53]
  v_cmp_gt_i32 s[52:53], 3, v5
  v_cndmask_b32 v217, v4, 0, s[54:55]
  v_cndmask_b32 v233, 0, v4, s[54:55]
  v_cmp_gt_i32 s[54:55], 19, v5
  v_cndmask_b32 v218, v4, 0, s[52:53]
  v_cndmask_b32 v234, 0, v4, s[52:53]
  v_cmp_gt_i32 s[52:53], 8, v5
  v_cndmask_b32 v219, v4, 0, s[54:55]
  v_cndmask_b32 v235, 0, v4, s[54:55]
  v_cmp_gt_i32 s[54:55], 24, v5
  v_cndmask_b32 v220, v4, 0, s[52:53]
  v_cndmask_b32 v236, 0, v4, s[52:53]
  v_cmp_gt_i32 s[52:53], 9, v5
  v_cndmask_b32 v221, v4, 0, s[54:55]
  v_cndmask_b32 v237, 0, v4, s[54:55]
  v_cmp_gt_i32 s[54:55], 25, v5
  v_cndmask_b32 v222, v4, 0, s[52:53]
  v_cndmask_b32 v238, 0, v4, s[52:53]
  v_cmp_gt_i32 s[52:53], 10, v5
  v_cndmask_b32 v223, v4, 0, s[54:55]
  v_cndmask_b32 v239, 0, v4, s[54:55]
  v_cmp_gt_i32 s[54:55], 26, v5
  v_cndmask_b32 v224, v4, 0, s[52:53]
  v_cndmask_b32 v240, 0, v4, s[52:53]
  v_cmp_gt_i32 s[52:53], 11, v5
  v_cndmask_b32 v225, v4, 0, s[54:55]
  v_cndmask_b32 v241, 0, v4, s[54:55]
  v_cmp_gt_i32 s[54:55], 27, v5
  s_nop 1
  v_cndmask_b32 v226, v4, 0, s[52:53]
  v_cndmask_b32 v242, 0, v4, s[52:53]
  v_cndmask_b32 v227, v4, 0, s[54:55]
  v_cndmask_b32 v243, 0, v4, s[54:55]
  s_cmp_lg_u32 s51, 0
  s_cbranch_scc1 L_mf_ok_l
  v_mov_b32 v212, v4
  v_mov_b32 v213, v4
  v_mov_b32 v214, v4
  v_mov_b32 v215, v4
  v_mov_b32 v216, v4
  v_mov_b32 v217, v4
  v_mov_b32 v218, v4
  v_mov_b32 v219, v4
  v_mov_b32 v220, v4
  v_mov_b32 v221, v4
  v_mov_b32 v222, v4
  v_mov_b32 v223, v4
  v_mov_b32 v224, v4
  v_mov_b32 v225, v4
  v_mov_b32 v226, v4
  v_mov_b32 v227, v4
L_mf_ok_l:
  v_lshrrev_b32 v3, 4, v255
  v_and_b32 v4, 15, v255
  v_lshlrev_b32 v250, 14, v3
  v_lshl_add_u32 v250, v4, 4, v250
  v_lshrrev_b32 v5, 5, v1
  v_lshl_add_u32 v250, v5, 8, v250
  v_lshlrev_b32 v251, 12, v3
  v_lshl_add_u32 v251, v4, 3, v251
  s_lshl_b32 s50, s97, 6
  v_add_u32 v2, s50, v1
  v_mul_u32_u24 v3, 52429, v2
  v_lshrrev_b32 v3, 19, v3
  v_mul_u32_u24 v4, 10, v3
  v_sub_u32 v6, v2, v4
  v_mul_u32_u24 v3, 1280, v3
  v_lshl_add_u32 v254, v6, 4, v3
  v_mov_b32 v96, 0
  v_mov_b32 v97, 0
  v_mov_b32 v98, 0
  v_mov_b32 v99, 0
  v_mov_b32 v100, 0
  v_mov_b32 v101, 0
  v_mov_b32 v102, 0
  v_mov_b32 v103, 0
  v_mov_b32 v104, 0
  v_mov_b32 v105, 0
  v_mov_b32 v106, 0
  v_mov_b32 v107, 0
  v_mov_b32 v108, 0
  v_mov_b32 v109, 0
  v_mov_b32 v110, 0
  v_mov_b32 v111, 0
  v_mov_b32 v112, 0
  v_mov_b32 v113, 0
  v_mov_b32 v114, 0
  v_mov_b32 v115, 0
  v_mov_b32 v116, 0
  v_mov_b32 v117, 0
  v_mov_b32 v118, 0
  v_mov_b32 v119, 0
  v_mov_b32 v120, 0
  v_mov_b32 v121, 0
  v_mov_b32 v122, 0
  v_mov_b32 v123, 0
  v_mov_b32 v124, 0
  v_mov_b32 v125, 0
  v_mov_b32 v126, 0
  v_mov_b32 v127, 0
  s_mov_b32 s36, 0
L_p1_ld_loop:
  s_waitcnt vmcnt(8)
  s_cmp_lg_u32 s36, 15
  s_cbranch_scc1 L_p1_ld_w1
  s_cmp_lg_u32 s97, 4
  s_cbranch_scc1 L_p1_ld_w1
  s_and_b32 s52, s96, 7
  s_lshr_b32 s53, s96, 3
  s_lshl_b32 s50, s52, 2
  s_lshr_b32 s52, s53, 3
  s_add_u32 s50, s50, s52
  s_and_b32 s51, s53, 7
  s_mul_i32 s50, s50, 20
  s_lshr_b32 s51, s50, 7
  s_add_u32 s50, s50, 19
  s_lshr_b32 s50, s50, 7
  s_sub_u32 s50, s50, s51
  v_bfe_u32 v2, v1, 4, 1
  v_mul_u32_u24 v2, s50, v2
  v_add_u32 v2, s51, v2
  v_lshrrev_b32 v5, 5, v1
  v_mul_u32_u24 v5, 5, v5
  v_add_u32 v5, v5, v2
  v_add_u32 v14, 10, v2
  v_and_b32 v2, 15, v1
  v_lshl_add_u32 v5, v5, 4, v2
  v_lshl_add_u32 v14, v14, 4, v2
  v_lshlrev_b32 v5, 7, v5
  v_lshlrev_b32 v14, 7, v14
  v_add_u32 v5, 21002240, v5
  v_add_u32 v14, 21002240, v14
  s_mov_b32 s58, 0x40000
L_poll_b:
  global_load_dword v3, v5, s[100:101] sc1
  global_load_dword v4, v14, s[100:101] sc1
  s_waitcnt vmcnt(0)
  v_cmp_eq_u32 s[56:57], s59, v3
  v_cmp_eq_u32 vcc, s59, v4
  s_nop 4
  s_and_b64 s[56:57], s[56:57], vcc
  s_and_b32 s56, s56, 0xffffffff
  s_and_b32 s57, s57, 0xffffffff
  s_cmp_lg_u32 s56, 0xffffffff
  s_cbranch_scc1 L_polln_b
  s_cmp_eq_u32 s57, 0xffffffff
  s_cbranch_scc1 L_polld_b
L_polln_b:
  s_sleep 1
  s_sub_u32 s58, s58, 1
  s_cmp_lg_u32 s58, 0
  s_cbranch_scc1 L_poll_b
L_polld_b:
L_p1_ld_w1:
  s_barrier
  s_cmp_lg_u32 s97, 4
  s_cbranch_scc1 L_p1_ld_h1
  s_cmp_lg_u32 s36, 8
  s_cbranch_scc1 L_p1_ld_h0
  s_mov_b32 s58, 0x40000
  v_mov_b32 v2, 0
L_tok_p1:
  global_load_dword v3, v2, s[98:99] sc1
  s_waitcnt vmcnt(0)
  v_readfirstlane_b32 s59, v3
  s_nop 3
  s_cmp_lg_u32 s59, 0
  s_cbranch_scc1 L_tokd_p1
  s_sleep 4
  s_sub_u32 s58, s58, 1
  s_cmp_lg_u32 s58, 0
  s_cbranch_scc1 L_tok_p1
L_tokd_p1:
L_p1_ld_h0:
  s_cmp_lg_u32 s36, 11
  s_cbranch_scc1 L_p1_ld_h1
  s_add_u32 s50, s28, 15
  s_lshl_b32 s50, s50, 4
  s_add_u32 s50, s50, s27
  s_lshl_b32 s50, s50, 7
  s_add_u32 s50, s50, 20971520
  s_mov_b64 exec, 1
  v_mov_b32 v2, s50
  v_mov_b32 v3, s59
  global_store_dword v2, v3, s[100:101] sc1
  s_mov_b64 exec, -1
L_p1_ld_h1:
  s_cmp_lg_u32 s36, 7
  s_cbranch_scc1 L_p1_ld_h2
  s_mov_b32 s4, s16
  s_and_b32 s5, s17, 0xffff
  s_mov_b32 s6, 2621440
  s_mov_b32 s7, 0x20000
  s_mov_b32 s8, s18
  s_and_b32 s9, s19, 0xffff
  s_mov_b32 s10, 2457600
  s_mov_b32 s11, 0x20000
L_p1_ld_h2:
  s_mul_i32 s34, s31, 245760
  s_lshl_b32 s32, s31, 7
  s_lshl_b32 s37, s35, 15
  s_lshr_b32 s44, s35, 1
  s_lshl_b32 s44, s44, 14
  s_add_u32 s37, s37, s44
  s_add_u32 s37, s37, 16384
  s_add_u32 s41, s37, s38
  s_add_u32 s42, s37, s39
  s_add_u32 m0, s41, 0
  s_nop 0
  buffer_load_dwordx4 v8, s[8:11], s34 offen  lds
  s_add_u32 m0, s42, 0
  s_nop 0
  buffer_load_dwordx4 v10, s[4:7], s32 offen  lds
  s_add_u32 m0, s41, 1024
  s_add_u32 s43, s34, 15360
  buffer_load_dwordx4 v8, s[8:11], s43 offen  lds
  s_add_u32 m0, s42, 1024
  s_nop 0
  buffer_load_dwordx4 v11, s[4:7], s32 offen  lds
  s_add_u32 m0, s41, 2048
  s_nop 0
  buffer_load_dwordx4 v9, s[8:11], s34 offen  lds
  s_add_u32 m0, s42, 2048
  s_add_u32 s32, s32, 20480
  buffer_load_dwordx4 v10, s[4:7], s32 offen  lds
  s_add_u32 m0, s41, 3072
  s_add_u32 s43, s34, 15360
  buffer_load_dwordx4 v9, s[8:11], s43 offen  lds
  s_add_u32 m0, s42, 3072
  s_nop 0
  buffer_load_dwordx4 v11, s[4:7], s32 offen  lds
  s_add_u32 s31, s31, 1
  s_cmp_eq_u32 s31, 10
  s_cselect_b32 s31, 0, s31
  s_add_u32 s35, s35, 1
  s_and_b32 s35, s35, 3
  s_add_u32 s36, s36, 1
  s_cmp_lt_u32 s36, 16
  s_cbranch_scc1 L_p1_ld_loop
  s_setprio 1
  s_lshl_b32 s48, s29, 11
  s_and_b32 s52, s96, 7
  s_lshr_b32 s53, s96, 3
  s_lshl_b32 s50, s52, 2
  s_lshr_b32 s52, s53, 3
  s_add_u32 s50, s50, s52
  s_and_b32 s51, s53, 7
  s_lshl_b32 s50, s50, 6
  s_lshl_b32 s51, s51, 3
  s_add_u32 s50, s50, s51
  s_and_b32 s51, s97, 3
  s_lshl_b32 s51, s51, 1
  s_add_u32 s50, s50, s51
  s_mul_i32 s50, s50, 1280
  s_add_u32 s50, s50, 2621440
  s_add_u32 s51, s50, 1280
  s_mov_b32 s52, s100
  s_and_b32 s53, s101, 0xffff
  s_mov_b32 s54, 15728640
  s_mov_b32 s55, 0x20000
  v_and_b32 v5, 31, v1
  v_lshlrev_b32 v5, 3, v5
  v_lshrrev_b32 v4, 5, v1
  v_mul_u32_u24 v33, 1280, v4
  v_lshl_add_u32 v4, v4, 8, v5
  v_add3_u32 v5, v5, v33, 0
  v_add_u32 v5, 1024, v5
  buffer_load_dwordx2 v[16:17], v4, s[52:55], s50 offen
  buffer_load_dwordx2 v[18:19], v4, s[52:55], s50 offen offset:512
  buffer_load_dwordx2 v[24:25], v4, s[52:55], s51 offen
  buffer_load_dwordx2 v[26:27], v4, s[52:55], s51 offen offset:512
  buffer_load_dwordx2 v[20:21], v5, s[52:55], s50 offen
  s_and_b32 s52, s96, 7
  s_lshr_b32 s53, s96, 3
  s_lshl_b32 s50, s52, 2
  s_lshr_b32 s52, s53, 3
  s_add_u32 s50, s50, s52
  s_and_b32 s51, s53, 7
  s_mul_i32 s50, s50, 163840
  s_add_u32 s50, s50, 10485760
  s_add_u32 s52, s100, s50
  s_addc_u32 s53, s101, 0
  s_and_b32 s53, s53, 0xffff
  s_mov_b32 s54, 163840
  s_mov_b32 s55, 0x20000
  v_lshlrev_b32 v2, 4, v1
  s_add_u32 m0, s48, 0
  s_add_u32 s50, s48, 0
  buffer_load_dwordx4 v2, s[52:55], s50 offen  lds
  s_add_u32 m0, s48, 1024
  s_add_u32 s50, s48, 1024
  buffer_load_dwordx4 v2, s[52:55], s50 offen  lds
  s_add_u32 m0, s48, 81920
  s_add_u32 s50, s48, 81920
  buffer_load_dwordx4 v2, s[52:55], s50 offen  lds
  s_add_u32 m0, s48, 82944
  s_add_u32 s50, s48, 82944
  buffer_load_dwordx4 v2, s[52:55], s50 offen  lds
  s_add_u32 m0, s48, 8192
  s_add_u32 s50, s48, 8192
  buffer_load_dwordx4 v2, s[52:55], s50 offen  lds
  s_add_u32 m0, s48, 9216
  s_add_u32 s50, s48, 9216
  buffer_load_dwordx4 v2, s[52:55], s50 offen  lds
  s_add_u32 m0, s48, 90112
  s_add_u32 s50, s48, 90112
  buffer_load_dwordx4 v2, s[52:55], s50 offen  lds
  s_add_u32 m0, s48, 91136
  s_add_u32 s50, s48, 91136
  buffer_load_dwordx4 v2, s[52:55], s50 offen  lds
  s_mov_b32 s3, 1
L_early:
  s_mov_b32 s24, 0xfffff
  s_mov_b32 s25, 0xfffff
  v_cmp_eq_u32 s[40:41], 20, v249
  v_mov_b32 v3, 0x3f803f80
  s_nop 0
  v_cndmask_b32 v3, 0, v3, s[40:41]
  v_mov_b32 v36, v3
  v_mov_b32 v37, v3
  v_mov_b32 v38, v3
  v_mov_b32 v39, v3
  v_mov_b32 v40, v3
  v_mov_b32 v41, v3
  v_mov_b32 v42, v3
  v_mov_b32 v43, v3
  v_mov_b32 v44, v3
  v_mov_b32 v45, v3
  v_mov_b32 v46, v3
  v_mov_b32 v47, v3
  v_mov_b32 v48, v3
  v_mov_b32 v49, v3
  v_mov_b32 v50, v3
  v_mov_b32 v51, v3
  v_mov_b32 v56, 0
  v_mov_b32 v57, 0
  v_mov_b32 v58, 0
  v_mov_b32 v59, 0
  v_mov_b32 v12, v244
  v_mov_b32 v13, v245
  v_mov_b32 v14, v246
  v_mov_b32 v15, v247
  v_add_u32 v244, 81920, v244
  v_add_u32 v245, 81920, v245
  v_add_u32 v246, 81920, v246
  v_add_u32 v247, 81920, v247
  s_cmp_eq_u32 s3, 0
  s_cbranch_scc1 L_eh0
  s_waitcnt vmcnt(21)
  s_barrier
  s_mul_i32 s34, s31, 245760
  s_lshl_b32 s32, s31, 7
  s_lshl_b32 s37, s35, 15
  s_lshr_b32 s44, s35, 1
  s_lshl_b32 s44, s44, 14
  s_add_u32 s37, s37, s44
  s_add_u32 s37, s37, 16384
  s_add_u32 s41, s37, s38
  s_add_u32 s42, s37, s39
  s_add_u32 m0, s41, 0
  s_nop 0
  buffer_load_dwordx4 v8, s[8:11], s34 offen  lds
  s_add_u32 m0, s42, 0
  s_nop 0
  buffer_load_dwordx4 v10, s[4:7], s32 offen  lds
  s_add_u32 m0, s41, 1024
  s_add_u32 s43, s34, 15360
  buffer_load_dwordx4 v8, s[8:11], s43 offen  lds
  s_add_u32 m0, s42, 1024
  s_nop 0
  buffer_load_dwordx4 v11, s[4:7], s32 offen  lds
  s_add_u32 m0, s41, 2048
  s_nop 0
  buffer_load_dwordx4 v9, s[8:11], s34 offen  lds
  s_add_u32 m0, s42, 2048
  s_add_u32 s32, s32, 20480
  buffer_load_dwordx4 v10, s[4:7], s32 offen  lds
  s_add_u32 m0, s41, 3072
  s_add_u32 s43, s34, 15360
  buffer_load_dwordx4 v9, s[8:11], s43 offen  lds
  s_add_u32 m0, s42, 3072
  s_nop 0
  buffer_load_dwordx4 v11, s[4:7], s32 offen  lds
  s_add_u32 s31, s31, 1
  s_cmp_eq_u32 s31, 10
  s_cselect_b32 s31, 0, s31
  s_add_u32 s35, s35, 1
  s_and_b32 s35, s35, 3
L_eh0:
  s_cmp_eq_u32 s3, 0
  s_cbranch_scc1 L_eh1
  s_waitcnt vmcnt(8)
  s_barrier
L_eh1:
  ds_read2st64_b64 v[28:31], v12 offset0:0 offset1:1
  ds_read_b64 v[32:33], v13 offset:0
  s_waitcnt lgkmcnt(0)
  v_mfma_f32_32x32x16_bf16 v[64:79], v[28:31], v[16:19], 0
  v_mfma_f32_32x32x16_bf16 v[80:95], v[28:31], v[24:27], 0
  s_nop 9
  v_mfma_f32_32x32x4bf16_1k v[64:95], v[32:33], v[20:21], v[64:95]
  ds_read2st64_b64 v[28:31], v244 offset0:0 offset1:1
  ds_read_b64 v[32:33], v245 offset:0
  s_mov_b64 exec, s[24:25]
  ds_read_b128 v[36:39], v246 offset:0
  ds_read_b128 v[40:43], v247 offset:0
  s_mov_b64 exec, -1
  s_nop 15
  s_nop 3
  v_max3_f32 v10, v64, v65, v66
  v_max3_f32 v10, v10, v67, v68
  v_max3_f32 v10, v10, v69, v70
  v_max3_f32 v10, v10, v71, v72
  v_max3_f32 v10, v10, v73, v74
  v_max3_f32 v10, v10, v75, v76
  v_max3_f32 v10, v10, v77, v78
  v_max_f32 v10, v10, v79
  v_max3_f32 v35, v80, v81, v82
  v_max3_f32 v35, v35, v83, v84
  v_max3_f32 v35, v35, v85, v86
  v_max3_f32 v35, v35, v87, v88
  v_max3_f32 v35, v35, v89, v90
  v_max3_f32 v35, v35, v91, v92
  v_max3_f32 v35, v35, v93, v94
  v_max_f32 v35, v35, v95
  v_mov_b32 v3, v10
  s_nop 1
  v_permlane32_swap_b32 v10, v3
  s_nop 1
  v_max_f32 v10, v10, v3
  v_mov_b32 v3, v35
  s_nop 1
  v_permlane32_swap_b32 v35, v3
  s_nop 1
  v_max_f32 v35, v35, v3
  v_sub_f32 v128, 0, v10
  v_sub_f32 v129, 0, v10
  v_sub_f32 v130, 0, v10
  v_sub_f32 v131, 0, v10
  v_sub_f32 v132, 0, v10
  v_sub_f32 v133, 0, v10
  v_sub_f32 v134, 0, v10
  v_sub_f32 v135, 0, v10
  v_sub_f32 v136, 0, v10
  v_sub_f32 v137, 0, v10
  v_sub_f32 v138, 0, v10
  v_sub_f32 v139, 0, v10
  v_sub_f32 v140, 0, v10
  v_sub_f32 v141, 0, v10
  v_sub_f32 v142, 0, v10
  v_sub_f32 v143, 0, v10
  v_sub_f32 v144, 0, v35
  v_sub_f32 v145, 0, v35
  v_sub_f32 v146, 0, v35
  v_sub_f32 v147, 0, v35
  v_sub_f32 v148, 0, v35
  v_sub_f32 v149, 0, v35
  v_sub_f32 v150, 0, v35
  v_sub_f32 v151, 0, v35
  v_sub_f32 v152, 0, v35
  v_sub_f32 v153, 0, v35
  v_sub_f32 v154, 0, v35
  v_sub_f32 v155, 0, v35
  v_sub_f32 v156, 0, v35
  v_sub_f32 v157, 0, v35
  v_sub_f32 v158, 0, v35
  v_sub_f32 v159, 0, v35
  s_waitcnt lgkmcnt(0)
  v_mfma_f32_32x32x16_bf16 v[64:79], v[28:31], v[16:19], v[128:143]
  v_mfma_f32_32x32x16_bf16 v[80:95], v[28:31], v[24:27], v[144:159]
  ds_read2st64_b64 v[28:31], v244 offset0:5 offset1:6
  s_nop 9
  v_mfma_f32_32x32x4bf16_1k v[64:95], v[32:33], v[20:21], v[64:95]
  ds_read_b64 v[32:33], v245 offset:2560
  s_nop 15
  s_nop 1
  s_waitcnt lgkmcnt(0)
  v_mfma_f32_32x32x16_bf16 v[160:175], v[28:31], v[16:19], v[128:143]
  v_exp_f32 v64, v64
  v_exp_f32 v65, v65
  v_exp_f32 v66, v66
  v_exp_f32 v67, v67
  v_mfma_f32_32x32x16_bf16 v[112:127], v[48:51], v[56:59], v[112:127]
  s_mov_b64 exec, s[24:25]
  ds_read_b128 v[44:47], v246 offset:2560
  ds_read_b128 v[48:51], v247 offset:2560
  s_mov_b64 exec, -1
  v_exp_f32 v68, v68
  v_exp_f32 v69, v69
  v_cvt_pk_bf16_f32 v52, v64, v65
  v_exp_f32 v70, v70
  v_cvt_pk_bf16_f32 v53, v66, v67
  v_exp_f32 v71, v71
  v_mfma_f32_32x32x16_bf16 v[176:191], v[28:31], v[24:27], v[144:159]
  ds_read2st64_b64 v[28:31], v244 offset0:10 offset1:11
  v_exp_f32 v72, v72
  v_cvt_pk_bf16_f32 v54, v68, v69
  v_exp_f32 v73, v73
  v_cvt_pk_bf16_f32 v55, v70, v71
  v_exp_f32 v74, v74
  v_exp_f32 v75, v75
  v_mfma_f32_32x32x16_bf16 v[96:111], v[36:39], v[52:55], v[96:111]
  v_exp_f32 v76, v76
  v_exp_f32 v77, v77
  v_cvt_pk_bf16_f32 v56, v72, v73
  v_exp_f32 v78, v78
  v_cvt_pk_bf16_f32 v57, v74, v75
  v_exp_f32 v79, v79
  v_cvt_pk_bf16_f32 v58, v76, v77
  v_cvt_pk_bf16_f32 v59, v78, v79
  v_mfma_f32_32x32x4bf16_1k v[160:191], v[32:33], v[20:21], v[160:191]
  ds_read_b64 v[32:33], v245 offset:5120
  v_exp_f32 v80, v80
  v_exp_f32 v81, v81
  v_exp_f32 v82, v82
  v_exp_f32 v83, v83
  v_exp_f32 v84, v84
  v_exp_f32 v85, v85
  v_cvt_pk_bf16_f32 v52, v80, v81
  v_exp_f32 v86, v86
  v_cvt_pk_bf16_f32 v53, v82, v83
  v_exp_f32 v87, v87
  v_mfma_f32_32x32x16_bf16 v[96:111], v[40:43], v[56:59], v[96:111]
  v_exp_f32 v88, v88
  v_cvt_pk_bf16_f32 v54, v84, v85
  v_exp_f32 v89, v89
  v_cvt_pk_bf16_f32 v55, v86, v87
  v_exp_f32 v90, v90
  v_exp_f32 v91, v91
  v_mfma_f32_32x32x16_bf16 v[112:127], v[36:39], v[52:55], v[112:127]
  v_exp_f32 v92, v92
  v_exp_f32 v93, v93
  v_cvt_pk_bf16_f32 v56, v88, v89
  v_exp_f32 v94, v94
  v_cvt_pk_bf16_f32 v57, v90, v91
  v_exp_f32 v95, v95
  v_cvt_pk_bf16_f32 v58, v92, v93
  v_cvt_pk_bf16_f32 v59, v94, v95
  s_cmp_eq_u32 s3, 0
  s_cbranch_scc1 L_eh2
  s_waitcnt vmcnt(0)
  s_barrier
  s_and_b32 s52, s96, 7
  s_lshr_b32 s53, s96, 3
  s_lshl_b32 s50, s52, 2
  s_lshr_b32 s52, s53, 3
  s_add_u32 s50, s50, s52
  s_and_b32 s51, s53, 7
  s_mul_i32 s50, s50, 163840
  s_add_u32 s50, s50, 10485760
  s_add_u32 s52, s100, s50
  s_addc_u32 s53, s101, 0
  s_and_b32 s53, s53, 0xffff
  s_mov_b32 s54, 163840
  s_mov_b32 s55, 0x20000
  v_lshlrev_b32 v2, 4, v1
  s_add_u32 m0, s48, 16384
  s_add_u32 s50, s48, 16384
  buffer_load_dwordx4 v2, s[52:55], s50 offen  lds
  s_add_u32 m0, s48, 17408
  s_add_u32 s50, s48, 17408
  buffer_load_dwordx4 v2, s[52:55], s50 offen  lds
  s_add_u32 m0, s48, 24576
  s_add_u32 s50, s48, 24576
  buffer_load_dwordx4 v2, s[52:55], s50 offen  lds
  s_add_u32 m0, s48, 25600
  s_add_u32 s50, s48, 25600
  buffer_load_dwordx4 v2, s[52:55], s50 offen  lds
  s_add_u32 m0, s48, 32768
  s_add_u32 s50, s48, 32768
  buffer_load_dwordx4 v2, s[52:55], s50 offen  lds
  s_add_u32 m0, s48, 33792
  s_add_u32 s50, s48, 33792
  buffer_load_dwordx4 v2, s[52:55], s50 offen  lds
  s_add_u32 m0, s48, 40960
  s_add_u32 s50, s48, 40960
  buffer_load_dwordx4 v2, s[52:55], s50 offen  lds
  s_add_u32 m0, s48, 41984
  s_add_u32 s50, s48, 41984
  buffer_load_dwordx4 v2, s[52:55], s50 offen  lds
L_eh2:
  s_waitcnt lgkmcnt(0)
  v_mfma_f32_32x32x16_bf16 v[64:79], v[28:31], v[16:19], v[128:143]
  v_exp_f32 v160, v160
  v_exp_f32 v161, v161
  v_exp_f32 v162, v162
  v_exp_f32 v163, v163
  v_mfma_f32_32x32x16_bf16 v[112:127], v[40:43], v[56:59], v[112:127]
  s_mov_b64 exec, s[24:25]
  ds_read_b128 v[36:39], v246 offset:5120
  ds_read_b128 v[40:43], v247 offset:5120
  s_mov_b64 exec, -1
  v_exp_f32 v164, v164
  v_exp_f32 v165, v165
  v_cvt_pk_bf16_f32 v52, v160, v161
  v_exp_f32 v166, v166
  v_cvt_pk_bf16_f32 v53, v162, v163
  v_exp_f32 v167, v167
  v_mfma_f32_32x32x16_bf16 v[80:95], v[28:31], v[24:27], v[144:159]
  ds_read2st64_b64 v[28:31], v244 offset0:15 offset1:16
  v_exp_f32 v168, v168
  v_cvt_pk_bf16_f32 v54, v164, v165
  v_exp_f32 v169, v169
  v_cvt_pk_bf16_f32 v55, v166, v167
  v_exp_f32 v170, v170
  v_exp_f32 v171, v171
  v_mfma_f32_32x32x16_bf16 v[96:111], v[44:47], v[52:55], v[96:111]
  v_exp_f32 v172, v172
  v_exp_f32 v173, v173
  v_cvt_pk_bf16_f32 v56, v168, v169
  v_exp_f32 v174, v174
  v_cvt_pk_bf16_f32 v57, v170, v171
  v_exp_f32 v175, v175
  v_cvt_pk_bf16_f32 v58, v172, v173
  v_cvt_pk_bf16_f32 v59, v174, v175
  v_mfma_f32_32x32x4bf16_1k v[64:95], v[32:33], v[20:21], v[64:95]
  ds_read_b64 v[32:33], v245 offset:7680
  v_exp_f32 v176, v176
  v_exp_f32 v177, v177
  v_exp_f32 v178, v178
  v_exp_f32 v179, v179
  v_exp_f32 v180, v180
  v_exp_f32 v181, v181
  v_cvt_pk_bf16_f32 v52, v176, v177
  v_exp_f32 v182, v182
  v_cvt_pk_bf16_f32 v53, v178, v179
  v_exp_f32 v183, v183
  v_mfma_f32_32x32x16_bf16 v[96:111], v[48:51], v[56:59], v[96:111]
  v_exp_f32 v184, v184
  v_cvt_pk_bf16_f32 v54, v180, v181
  v_exp_f32 v185, v185
  v_cvt_pk_bf16_f32 v55, v182, v183
  v_exp_f32 v186, v186
  v_exp_f32 v187, v187
  v_mfma_f32_32x32x16_bf16 v[112:127], v[44:47], v[52:55], v[112:127]
  v_exp_f32 v188, v188
  v_exp_f32 v189, v189
  v_cvt_pk_bf16_f32 v56, v184, v185
  v_exp_f32 v190, v190
  v_cvt_pk_bf16_f32 v57, v186, v187
  v_exp_f32 v191, v191
  v_cvt_pk_bf16_f32 v58, v188, v189
  v_cvt_pk_bf16_f32 v59, v190, v191
  s_cmp_eq_u32 s3, 0
  s_cbranch_scc1 L_eh3
  s_barrier
  s_and_b32 s52, s96, 7
  s_lshr_b32 s53, s96, 3
  s_lshl_b32 s50, s52, 2
  s_lshr_b32 s52, s53, 3
  s_add_u32 s50, s50, s52
  s_and_b32 s51, s53, 7
  s_mul_i32 s50, s50, 163840
  s_add_u32 s50, s50, 10485760
  s_add_u32 s52, s100, s50
  s_addc_u32 s53, s101, 0
  s_and_b32 s53, s53, 0xffff
  s_mov_b32 s54, 163840
  s_mov_b32 s55, 0x20000
  v_lshlrev_b32 v2, 4, v1
  s_add_u32 m0, s48, 98304
  s_add_u32 s50, s48, 98304
  buffer_load_dwordx4 v2, s[52:55], s50 offen  lds
  s_add_u32 m0, s48, 99328
  s_add_u32 s50, s48, 99328
  buffer_load_dwordx4 v2, s[52:55], s50 offen  lds
  s_add_u32 m0, s48, 106496
  s_add_u32 s50, s48, 106496
  buffer_load_dwordx4 v2, s[52:55], s50 offen  lds
  s_add_u32 m0, s48, 107520
  s_add_u32 s50, s48, 107520
  buffer_load_dwordx4 v2, s[52:55], s50 offen  lds
  s_add_u32 m0, s48, 114688
  s_add_u32 s50, s48, 114688
  buffer_load_dwordx4 v2, s[52:55], s50 offen  lds
  s_add_u32 m0, s48, 115712
  s_add_u32 s50, s48, 115712
  buffer_load_dwordx4 v2, s[52:55], s50 offen  lds
  s_add_u32 m0, s48, 122880
  s_add_u32 s50, s48, 122880
  buffer_load_dwordx4 v2, s[52:55], s50 offen  lds
  s_add_u32 m0, s48, 123904
  s_add_u32 s50, s48, 123904
  buffer_load_dwordx4 v2, s[52:55], s50 offen  lds
L_eh3:
  s_waitcnt lgkmcnt(0)
  v_mfma_f32_32x32x16_bf16 v[160:175], v[28:31], v[16:19], v[128:143]
  v_exp_f32 v64, v64
  v_exp_f32 v65, v65
  v_exp_f32 v66, v66
  v_exp_f32 v67, v67
  v_mfma_f32_32x32x16_bf16 v[112:127], v[48:51], v[56:59], v[112:127]
  s_mov_b64 exec, s[24:25]
  ds_read_b128 v[44:47], v246 offset:7680
  ds_read_b128 v[48:51], v247 offset:7680
  s_mov_b64 exec, -1
  v_exp_f32 v68, v68
  v_exp_f32 v69, v69
  v_cvt_pk_bf16_f32 v52, v64, v65
  v_exp_f32 v70, v70
  v_cvt_pk_bf16_f32 v53, v66, v67
  v_exp_f32 v71, v71
  v_mfma_f32_32x32x16_bf16 v[176:191], v[28:31], v[24:27], v[144:159]
  ds_read2st64_b64 v[28:31], v12 offset0:0 offset1:1
  v_exp_f32 v72, v72
  v_cvt_pk_bf16_f32 v54, v68, v69
  v_exp_f32 v73, v73
  v_cvt_pk_bf16_f32 v55, v70, v71
  v_exp_f32 v74, v74
  v_exp_f32 v75, v75
  v_mfma_f32_32x32x16_bf16 v[96:111], v[36:39], v[52:55], v[96:111]
  v_exp_f32 v76, v76
  v_exp_f32 v77, v77
  v_cvt_pk_bf16_f32 v56, v72, v73
  v_exp_f32 v78, v78
  v_cvt_pk_bf16_f32 v57, v74, v75
  v_exp_f32 v79, v79
  v_cvt_pk_bf16_f32 v58, v76, v77
  v_cvt_pk_bf16_f32 v59, v78, v79
  v_mfma_f32_32x32x4bf16_1k v[160:191], v[32:33], v[20:21], v[160:191]
  ds_read_b64 v[32:33], v13 offset:0
  v_exp_f32 v80, v80
  v_exp_f32 v81, v81
  v_exp_f32 v82, v82
  v_exp_f32 v83, v83
  v_exp_f32 v84, v84
  v_exp_f32 v85, v85
  v_cvt_pk_bf16_f32 v52, v80, v81
  v_exp_f32 v86, v86
  v_cvt_pk_bf16_f32 v53, v82, v83
  v_exp_f32 v87, v87
  v_mfma_f32_32x32x16_bf16 v[96:111], v[40:43], v[56:59], v[96:111]
  v_exp_f32 v88, v88
  v_cvt_pk_bf16_f32 v54, v84, v85
  v_exp_f32 v89, v89
  v_cvt_pk_bf16_f32 v55, v86, v87
  v_exp_f32 v90, v90
  v_exp_f32 v91, v91
  v_mfma_f32_32x32x16_bf16 v[112:127], v[36:39], v[52:55], v[112:127]
  v_exp_f32 v92, v92
  v_exp_f32 v93, v93
  v_cvt_pk_bf16_f32 v56, v88, v89
  v_exp_f32 v94, v94
  v_cvt_pk_bf16_f32 v57, v90, v91
  v_exp_f32 v95, v95
  v_cvt_pk_bf16_f32 v58, v92, v93
  v_cvt_pk_bf16_f32 v59, v94, v95
  s_waitcnt lgkmcnt(0)
  v_mfma_f32_32x32x16_bf16 v[64:79], v[28:31], v[16:19], v[128:143]
  v_exp_f32 v160, v160
  v_exp_f32 v161, v161
  v_exp_f32 v162, v162
  v_exp_f32 v163, v163
  v_mfma_f32_32x32x16_bf16 v[112:127], v[40:43], v[56:59], v[112:127]
  s_mov_b64 exec, s[24:25]
  ds_read_b128 v[36:39], v14 offset:0
  ds_read_b128 v[40:43], v15 offset:0
  s_mov_b64 exec, -1
  v_exp_f32 v164, v164
  v_exp_f32 v165, v165
  v_cvt_pk_bf16_f32 v52, v160, v161
  v_exp_f32 v166, v166
  v_cvt_pk_bf16_f32 v53, v162, v163
  v_exp_f32 v167, v167
  v_mfma_f32_32x32x16_bf16 v[80:95], v[28:31], v[24:27], v[144:159]
  ds_read2st64_b64 v[28:31], v12 offset0:5 offset1:6
  v_exp_f32 v168, v168
  v_cvt_pk_bf16_f32 v54, v164, v165
  v_exp_f32 v169, v169
  v_cvt_pk_bf16_f32 v55, v166, v167
  v_exp_f32 v170, v170
  v_exp_f32 v171, v171
  v_mfma_f32_32x32x16_bf16 v[96:111], v[44:47], v[52:55], v[96:111]
  v_exp_f32 v172, v172
  v_exp_f32 v173, v173
  v_cvt_pk_bf16_f32 v56, v168, v169
  v_exp_f32 v174, v174
  v_cvt_pk_bf16_f32 v57, v170, v171
  v_exp_f32 v175, v175
  v_cvt_pk_bf16_f32 v58, v172, v173
  v_cvt_pk_bf16_f32 v59, v174, v175
  v_mfma_f32_32x32x4bf16_1k v[64:95], v[32:33], v[20:21], v[64:95]
  ds_read_b64 v[32:33], v13 offset:2560
  v_exp_f32 v176, v176
  v_exp_f32 v177, v177
  v_exp_f32 v178, v178
  v_exp_f32 v179, v179
  v_exp_f32 v180, v180
  v_exp_f32 v181, v181
  v_cvt_pk_bf16_f32 v52, v176, v177
  v_exp_f32 v182, v182
  v_cvt_pk_bf16_f32 v53, v178, v179
  v_exp_f32 v183, v183
  v_mfma_f32_32x32x16_bf16 v[96:111], v[48:51], v[56:59], v[96:111]
  v_exp_f32 v184, v184
  v_cvt_pk_bf16_f32 v54, v180, v181
  v_exp_f32 v185, v185
  v_cvt_pk_bf16_f32 v55, v182, v183
  v_exp_f32 v186, v186
  v_exp_f32 v187, v187
  v_mfma_f32_32x32x16_bf16 v[112:127], v[44:47], v[52:55], v[112:127]
  v_exp_f32 v188, v188
  v_exp_f32 v189, v189
  v_cvt_pk_bf16_f32 v56, v184, v185
  v_exp_f32 v190, v190
  v_cvt_pk_bf16_f32 v57, v186, v187
  v_exp_f32 v191, v191
  v_cvt_pk_bf16_f32 v58, v188, v189
  v_cvt_pk_bf16_f32 v59, v190, v191
  s_waitcnt lgkmcnt(0)
  v_mfma_f32_32x32x16_bf16 v[160:175], v[28:31], v[16:19], v[128:143]
  v_exp_f32 v64, v64
  v_exp_f32 v65, v65
  v_exp_f32 v66, v66
  v_exp_f32 v67, v67
  v_mfma_f32_32x32x16_bf16 v[112:127], v[48:51], v[56:59], v[112:127]
  s_mov_b64 exec, s[24:25]
  ds_read_b128 v[44:47], v14 offset:2560
  ds_read_b128 v[48:51], v15 offset:2560
  s_mov_b64 exec, -1
  v_exp_f32 v68, v68
  v_exp_f32 v69, v69
  v_cvt_pk_bf16_f32 v52, v64, v65
  v_exp_f32 v70, v70
  v_cvt_pk_bf16_f32 v53, v66, v67
  v_exp_f32 v71, v71
  v_mfma_f32_32x32x16_bf16 v[176:191], v[28:31], v[24:27], v[144:159]
  ds_read2st64_b64 v[28:31], v12 offset0:10 offset1:11
  v_exp_f32 v72, v72
  v_cvt_pk_bf16_f32 v54, v68, v69
  v_exp_f32 v73, v73
  v_cvt_pk_bf16_f32 v55, v70, v71
  v_exp_f32 v74, v74
  v_exp_f32 v75, v75
  v_mfma_f32_32x32x16_bf16 v[96:111], v[36:39], v[52:55], v[96:111]
  v_exp_f32 v76, v76
  v_exp_f32 v77, v77
  v_cvt_pk_bf16_f32 v56, v72, v73
  v_exp_f32 v78, v78
  v_cvt_pk_bf16_f32 v57, v74, v75
  v_exp_f32 v79, v79
  v_cvt_pk_bf16_f32 v58, v76, v77
  v_cvt_pk_bf16_f32 v59, v78, v79
  v_mfma_f32_32x32x4bf16_1k v[160:191], v[32:33], v[20:21], v[160:191]
  ds_read_b64 v[32:33], v13 offset:5120
  v_exp_f32 v80, v80
  v_exp_f32 v81, v81
  v_exp_f32 v82, v82
  v_exp_f32 v83, v83
  v_exp_f32 v84, v84
  v_exp_f32 v85, v85
  v_cvt_pk_bf16_f32 v52, v80, v81
  v_exp_f32 v86, v86
  v_cvt_pk_bf16_f32 v53, v82, v83
  v_exp_f32 v87, v87
  v_mfma_f32_32x32x16_bf16 v[96:111], v[40:43], v[56:59], v[96:111]
  v_exp_f32 v88, v88
  v_cvt_pk_bf16_f32 v54, v84, v85
  v_exp_f32 v89, v89
  v_cvt_pk_bf16_f32 v55, v86, v87
  v_exp_f32 v90, v90
  v_exp_f32 v91, v91
  v_mfma_f32_32x32x16_bf16 v[112:127], v[36:39], v[52:55], v[112:127]
  v_exp_f32 v92, v92
  v_exp_f32 v93, v93
  v_cvt_pk_bf16_f32 v56, v88, v89
  v_exp_f32 v94, v94
  v_cvt_pk_bf16_f32 v57, v90, v91
  v_exp_f32 v95, v95
  v_cvt_pk_bf16_f32 v58, v92, v93
  v_cvt_pk_bf16_f32 v59, v94, v95
  s_waitcnt lgkmcnt(0)
  v_mfma_f32_32x32x16_bf16 v[64:79], v[28:31], v[16:19], v[128:143]
  v_exp_f32 v160, v160
  v_exp_f32 v161, v161
  v_exp_f32 v162, v162
  v_exp_f32 v163, v163
  v_mfma_f32_32x32x16_bf16 v[112:127], v[40:43], v[56:59], v[112:127]
  s_mov_b64 exec, s[24:25]
  ds_read_b128 v[36:39], v14 offset:5120
  ds_read_b128 v[40:43], v15 offset:5120
  s_mov_b64 exec, -1
  v_exp_f32 v164, v164
  v_exp_f32 v165, v165
  v_cvt_pk_bf16_f32 v52, v160, v161
  v_exp_f32 v166, v166
  v_cvt_pk_bf16_f32 v53, v162, v163
  v_exp_f32 v167, v167
  v_mfma_f32_32x32x16_bf16 v[80:95], v[28:31], v[24:27], v[144:159]
  ds_read2st64_b64 v[28:31], v12 offset0:15 offset1:16
  v_exp_f32 v168, v168
  v_cvt_pk_bf16_f32 v54, v164, v165
  v_exp_f32 v169, v169
  v_cvt_pk_bf16_f32 v55, v166, v167
  v_exp_f32 v170, v170
  v_exp_f32 v171, v171
  v_mfma_f32_32x32x16_bf16 v[96:111], v[44:47], v[52:55], v[96:111]
  v_exp_f32 v172, v172
  v_exp_f32 v173, v173
  v_cvt_pk_bf16_f32 v56, v168, v169
  v_exp_f32 v174, v174
  v_cvt_pk_bf16_f32 v57, v170, v171
  v_exp_f32 v175, v175
  v_cvt_pk_bf16_f32 v58, v172, v173
  v_cvt_pk_bf16_f32 v59, v174, v175
  v_mfma_f32_32x32x4bf16_1k v[64:95], v[32:33], v[20:21], v[64:95]
  ds_read_b64 v[32:33], v13 offset:7680
  v_exp_f32 v176, v176
  v_exp_f32 v177, v177
  v_exp_f32 v178, v178
  v_exp_f32 v179, v179
  v_exp_f32 v180, v180
  v_exp_f32 v181, v181
  v_cvt_pk_bf16_f32 v52, v176, v177
  v_exp_f32 v182, v182
  v_cvt_pk_bf16_f32 v53, v178, v179
  v_exp_f32 v183, v183
  v_mfma_f32_32x32x16_bf16 v[96:111], v[48:51], v[56:59], v[96:111]
  v_exp_f32 v184, v184
  v_cvt_pk_bf16_f32 v54, v180, v181
  v_exp_f32 v185, v185
  v_cvt_pk_bf16_f32 v55, v182, v183
  v_exp_f32 v186, v186
  v_exp_f32 v187, v187
  v_mfma_f32_32x32x16_bf16 v[112:127], v[44:47], v[52:55], v[112:127]
  v_exp_f32 v188, v188
  v_exp_f32 v189, v189
  v_cvt_pk_bf16_f32 v56, v184, v185
  v_exp_f32 v190, v190
  v_cvt_pk_bf16_f32 v57, v186, v187
  v_exp_f32 v191, v191
  v_cvt_pk_bf16_f32 v58, v188, v189
  v_cvt_pk_bf16_f32 v59, v190, v191
  s_waitcnt lgkmcnt(0)
  v_mfma_f32_32x32x16_bf16 v[160:175], v[28:31], v[16:19], v[128:143]
  v_exp_f32 v64, v64
  v_exp_f32 v65, v65
  v_exp_f32 v66, v66
  v_exp_f32 v67, v67
  v_mfma_f32_32x32x16_bf16 v[112:127], v[48:51], v[56:59], v[112:127]
  s_mov_b64 exec, s[24:25]
  ds_read_b128 v[44:47], v14 offset:7680
  ds_read_b128 v[48:51], v15 offset:7680
  s_mov_b64 exec, -1
  v_exp_f32 v68, v68
  v_exp_f32 v69, v69
  v_cvt_pk_bf16_f32 v52, v64, v65
  v_exp_f32 v70, v70
  v_cvt_pk_bf16_f32 v53, v66, v67
  v_exp_f32 v71, v71
  v_mfma_f32_32x32x16_bf16 v[176:191], v[28:31], v[24:27], v[144:159]
  ds_read2st64_b64 v[28:31], v244 offset0:20 offset1:21
  v_exp_f32 v72, v72
  v_cvt_pk_bf16_f32 v54, v68, v69
  v_exp_f32 v73, v73
  v_cvt_pk_bf16_f32 v55, v70, v71
  v_exp_f32 v74, v74
  v_exp_f32 v75, v75
  v_mfma_f32_32x32x16_bf16 v[96:111], v[36:39], v[52:55], v[96:111]
  v_exp_f32 v76, v76
  v_exp_f32 v77, v77
  v_cvt_pk_bf16_f32 v56, v72, v73
  v_exp_f32 v78, v78
  v_cvt_pk_bf16_f32 v57, v74, v75
  v_exp_f32 v79, v79
  v_cvt_pk_bf16_f32 v58, v76, v77
  v_cvt_pk_bf16_f32 v59, v78, v79
  v_mfma_f32_32x32x4bf16_1k v[160:191], v[32:33], v[20:21], v[160:191]
  ds_read_b64 v[32:33], v245 offset:10240
  v_exp_f32 v80, v80
  v_exp_f32 v81, v81
  v_exp_f32 v82, v82
  v_exp_f32 v83, v83
  v_exp_f32 v84, v84
  v_exp_f32 v85, v85
  v_cvt_pk_bf16_f32 v52, v80, v81
  v_exp_f32 v86, v86
  v_cvt_pk_bf16_f32 v53, v82, v83
  v_exp_f32 v87, v87
  v_mfma_f32_32x32x16_bf16 v[96:111], v[40:43], v[56:59], v[96:111]
  v_exp_f32 v88, v88
  v_cvt_pk_bf16_f32 v54, v84, v85
  v_exp_f32 v89, v89
  v_cvt_pk_bf16_f32 v55, v86, v87
  v_exp_f32 v90, v90
  v_exp_f32 v91, v91
  v_mfma_f32_32x32x16_bf16 v[112:127], v[36:39], v[52:55], v[112:127]
  v_exp_f32 v92, v92
  v_exp_f32 v93, v93
  v_cvt_pk_bf16_f32 v56, v88, v89
  v_exp_f32 v94, v94
  v_cvt_pk_bf16_f32 v57, v90, v91
  v_exp_f32 v95, v95
  v_cvt_pk_bf16_f32 v58, v92, v93
  v_cvt_pk_bf16_f32 v59, v94, v95
  s_waitcnt lgkmcnt(0)
  v_mfma_f32_32x32x16_bf16 v[64:79], v[28:31], v[16:19], v[128:143]
  v_exp_f32 v160, v160
  v_exp_f32 v161, v161
  v_exp_f32 v162, v162
  v_exp_f32 v163, v163
  v_mfma_f32_32x32x16_bf16 v[112:127], v[40:43], v[56:59], v[112:127]
  s_mov_b64 exec, s[24:25]
  ds_read_b128 v[36:39], v246 offset:10240
  ds_read_b128 v[40:43], v247 offset:10240
  s_mov_b64 exec, -1
  v_exp_f32 v164, v164
  v_exp_f32 v165, v165
  v_cvt_pk_bf16_f32 v52, v160, v161
  v_exp_f32 v166, v166
  v_cvt_pk_bf16_f32 v53, v162, v163
  v_exp_f32 v167, v167
  v_mfma_f32_32x32x16_bf16 v[80:95], v[28:31], v[24:27], v[144:159]
  ds_read2st64_b64 v[28:31], v244 offset0:25 offset1:26
  v_exp_f32 v168, v168
  v_cvt_pk_bf16_f32 v54, v164, v165
  v_exp_f32 v169, v169
  v_cvt_pk_bf16_f32 v55, v166, v167
  v_exp_f32 v170, v170
  v_exp_f32 v171, v171
  v_mfma_f32_32x32x16_bf16 v[96:111], v[44:47], v[52:55], v[96:111]
  v_exp_f32 v172, v172
  v_exp_f32 v173, v173
  v_cvt_pk_bf16_f32 v56, v168, v169
  v_exp_f32 v174, v174
  v_cvt_pk_bf16_f32 v57, v170, v171
  v_exp_f32 v175, v175
  v_cvt_pk_bf16_f32 v58, v172, v173
  v_cvt_pk_bf16_f32 v59, v174, v175
  v_mfma_f32_32x32x4bf16_1k v[64:95], v[32:33], v[20:21], v[64:95]
  ds_read_b64 v[32:33], v245 offset:12800
  v_exp_f32 v176, v176
  v_exp_f32 v177, v177
  v_exp_f32 v178, v178
  v_exp_f32 v179, v179
  v_exp_f32 v180, v180
  v_exp_f32 v181, v181
  v_cvt_pk_bf16_f32 v52, v176, v177
  v_exp_f32 v182, v182
  v_cvt_pk_bf16_f32 v53, v178, v179
  v_exp_f32 v183, v183
  v_mfma_f32_32x32x16_bf16 v[96:111], v[48:51], v[56:59], v[96:111]
  v_exp_f32 v184, v184
  v_cvt_pk_bf16_f32 v54, v180, v181
  v_exp_f32 v185, v185
  v_cvt_pk_bf16_f32 v55, v182, v183
  v_exp_f32 v186, v186
  v_exp_f32 v187, v187
  v_mfma_f32_32x32x16_bf16 v[112:127], v[44:47], v[52:55], v[112:127]
  v_exp_f32 v188, v188
  v_exp_f32 v189, v189
  v_cvt_pk_bf16_f32 v56, v184, v185
  v_exp_f32 v190, v190
  v_cvt_pk_bf16_f32 v57, v186, v187
  v_exp_f32 v191, v191
  v_cvt_pk_bf16_f32 v58, v188, v189
  v_cvt_pk_bf16_f32 v59, v190, v191
  s_setprio 0
  s_cmp_eq_u32 s3, 0
  s_cbranch_scc1 L_p1_idle_done
  s_lshl_b32 s49, s28, 4
  s_add_u32 s49, s49, s27
  s_lshl_b32 s49, s49, 7
  s_or_b32 s49, s49, 0x80000000
  s_branch L_p1_done
L_p1_idle_done:
  s_mov_b32 s49, 0
  s_branch L_p1_done
L_p1_compute:
  s_and_b32 s52, s96, 7
  s_lshr_b32 s53, s96, 3
  s_lshl_b32 s50, s52, 2
  s_lshr_b32 s52, s53, 3
  s_add_u32 s50, s50, s52
  s_and_b32 s51, s53, 7
  v_lshlrev_b32 v248, 4, v1
  v_and_b32 v249, 31, v1
  v_lshlrev_b32 v3, 3, v249
  v_add_u32 v245, 1024, v3
  v_mov_b32 v4, 0x70000000
  v_cmp_gt_u32 s[56:57], 32, v1
  s_nop 1
  v_cndmask_b32 v253, v4, v245, s[56:57]
  v_lshrrev_b32 v2, 5, v1
  v_lshlrev_b32 v244, 3, v249
  v_lshl_add_u32 v244, v2, 8, v244
  v_mov_b32 v252, v244
  v_bfe_u32 v3, v249, 2, 2
  v_xor_b32 v3, v3, v2
  v_lshlrev_b32 v3, 4, v3
  v_lshl_add_u32 v246, v249, 6, v3
  v_add_u32 v246, 1280, v246
  v_xor_b32 v247, 32, v246
  v_and_b32 v3, 1, v249
  v_lshlrev_b32 v255, 4, v3
  v_lshrrev_b32 v3, 4, v249
  v_lshl_or_b32 v255, v3, 3, v255
  v_and_b32 v3, 4, v249
  v_or_b32 v255, v255, v3
  v_bfe_u32 v3, v249, 3, 1
  v_lshl_or_b32 v255, v3, 1, v255
  v_bfe_u32 v3, v249, 1, 1
  v_or_b32 v255, v255, v3
  v_lshlrev_b32 v5, 2, v2
  v_sub_u32 v5, v255, v5
  v_mov_b32 v4, 0xf149f2ca
  v_cmp_gt_i32 s[52:53], 0, v5
  s_nop 0
  v_cmp_gt_i32 s[54:55], 16, v5
  s_nop 1
  v_cndmask_b32 v212, v4, 0, s[52:53]
  v_cndmask_b32 v228, 0, v4, s[52:53]
  v_cmp_gt_i32 s[52:53], 1, v5
  v_cndmask_b32 v213, v4, 0, s[54:55]
  v_cndmask_b32 v229, 0, v4, s[54:55]
  v_cmp_gt_i32 s[54:55], 17, v5
  v_cndmask_b32 v214, v4, 0, s[52:53]
  v_cndmask_b32 v230, 0, v4, s[52:53]
  v_cmp_gt_i32 s[52:53], 2, v5
  v_cndmask_b32 v215, v4, 0, s[54:55]
  v_cndmask_b32 v231, 0, v4, s[54:55]
  v_cmp_gt_i32 s[54:55], 18, v5
  v_cndmask_b32 v216, v4, 0, s[52:53]
  v_cndmask_b32 v232, 0, v4, s[52:53]
  v_cmp_gt_i32 s[52:53], 3, v5
  v_cndmask_b32 v217, v4, 0, s[54:55]
  v_cndmask_b32 v233, 0, v4, s[54:55]
  v_cmp_gt_i32 s[54:55], 19, v5
  v_cndmask_b32 v218, v4, 0, s[52:53]
  v_cndmask_b32 v234, 0, v4, s[52:53]
  v_cmp_gt_i32 s[52:53], 8, v5
  v_cndmask_b32 v219, v4, 0, s[54:55]
  v_cndmask_b32 v235, 0, v4, s[54:55]
  v_cmp_gt_i32 s[54:55], 24, v5
  v_cndmask_b32 v220, v4, 0, s[52:53]
  v_cndmask_b32 v236, 0, v4, s[52:53]
  v_cmp_gt_i32 s[52:53], 9, v5
  v_cndmask_b32 v221, v4, 0, s[54:55]
  v_cndmask_b32 v237, 0, v4, s[54:55]
  v_cmp_gt_i32 s[54:55], 25, v5
  v_cndmask_b32 v222, v4, 0, s[52:53]
  v_cndmask_b32 v238, 0, v4, s[52:53]
  v_cmp_gt_i32 s[52:53], 10, v5
  v_cndmask_b32 v223, v4, 0, s[54:55]
  v_cndmask_b32 v239, 0, v4, s[54:55]
  v_cmp_gt_i32 s[54:55], 26, v5
  v_cndmask_b32 v224, v4, 0, s[52:53]
  v_cndmask_b32 v240, 0, v4, s[52:53]
  v_cmp_gt_i32 s[52:53], 11, v5
  v_cndmask_b32 v225, v4, 0, s[54:55]
  v_cndmask_b32 v241, 0, v4, s[54:55]
  v_cmp_gt_i32 s[54:55], 27, v5
  s_nop 1
  v_cndmask_b32 v226, v4, 0, s[52:53]
  v_cndmask_b32 v242, 0, v4, s[52:53]
  v_cndmask_b32 v227, v4, 0, s[54:55]
  v_cndmask_b32 v243, 0, v4, s[54:55]
  s_cmp_lg_u32 s51, 0
  s_cbranch_scc1 L_mf_ok_c
  v_mov_b32 v212, v4
  v_mov_b32 v213, v4
  v_mov_b32 v214, v4
  v_mov_b32 v215, v4
  v_mov_b32 v216, v4
  v_mov_b32 v217, v4
  v_mov_b32 v218, v4
  v_mov_b32 v219, v4
  v_mov_b32 v220, v4
  v_mov_b32 v221, v4
  v_mov_b32 v222, v4
  v_mov_b32 v223, v4
  v_mov_b32 v224, v4
  v_mov_b32 v225, v4
  v_mov_b32 v226, v4
  v_mov_b32 v227, v4
L_mf_ok_c:
  v_lshrrev_b32 v3, 4, v255
  v_and_b32 v4, 15, v255
  v_lshlrev_b32 v250, 14, v3
  v_lshl_add_u32 v250, v4, 4, v250
  v_lshrrev_b32 v5, 5, v1
  v_lshl_add_u32 v250, v5, 8, v250
  v_lshlrev_b32 v251, 12, v3
  v_lshl_add_u32 v251, v4, 3, v251
  s_lshl_b32 s50, s97, 6
  v_add_u32 v2, s50, v1
  v_mul_u32_u24 v3, 52429, v2
  v_lshrrev_b32 v3, 19, v3
  v_mul_u32_u24 v4, 10, v3
  v_sub_u32 v6, v2, v4
  v_mul_u32_u24 v3, 1280, v3
  v_lshl_add_u32 v254, v6, 4, v3
  s_and_b32 s29, s97, 1
  s_lshr_b32 s33, s97, 1
  v_and_b32 v11, 15, v1
  v_lshrrev_b32 v12, 4, v1
  v_and_b32 v6, 3, v1
  v_bfe_u32 v7, v1, 2, 2
  v_and_b32 v8, 1, v12
  v_lshl_or_b32 v8, v8, 2, v7
  v_lshl_add_u32 v9, v12, 3, v7
  v_lshlrev_b32 v9, 8, v9
  v_lshl_add_u32 v9, v6, 3, v9
  s_lshl_b32 s41, s33, 2
  v_xor_b32 v8, s41, v8
  v_xor_b32 v10, 0, v8
  v_lshl_add_u32 v14, v10, 5, v9
  v_xor_b32 v10, 1, v8
  v_lshl_add_u32 v15, v10, 5, v9
  v_xor_b32 v10, 2, v8
  v_lshl_add_u32 v16, v10, 5, v9
  v_xor_b32 v10, 3, v8
  v_lshl_add_u32 v17, v10, 5, v9
  v_lshrrev_b32 v6, 1, v11
  v_xor_b32 v6, v6, v12
  v_lshlrev_b32 v6, 4, v6
  v_lshl_add_u32 v6, v11, 7, v6
  s_lshl_b32 s41, s29, 13
  s_add_u32 s41, s41, 16384
  v_add_u32 v18, s41, v6
  v_xor_b32 v2, 64, v6
  v_sub_u32 v2, v2, v6
  v_add_u32 v19, 16384, v14
  v_add_u32 v20, 16384, v15
  v_add_u32 v21, 16384, v16
  v_add_u32 v22, 16384, v17
  v_add_u32 v23, 16384, v18
  v_mov_b32 v84, 0
  v_mov_b32 v85, 0
  v_mov_b32 v86, 0
  v_mov_b32 v87, 0
  v_mov_b32 v88, 0
  v_mov_b32 v89, 0
  v_mov_b32 v90, 0
  v_mov_b32 v91, 0
  v_mov_b32 v92, 0
  v_mov_b32 v93, 0
  v_mov_b32 v94, 0
  v_mov_b32 v95, 0
  v_mov_b32 v96, 0
  v_mov_b32 v97, 0
  v_mov_b32 v98, 0
  v_mov_b32 v99, 0
  v_mov_b32 v100, 0
  v_mov_b32 v101, 0
  v_mov_b32 v102, 0
  v_mov_b32 v103, 0
  v_mov_b32 v104, 0
  v_mov_b32 v105, 0
  v_mov_b32 v106, 0
  v_mov_b32 v107, 0
  v_mov_b32 v108, 0
  v_mov_b32 v109, 0
  v_mov_b32 v110, 0
  v_mov_b32 v111, 0
  v_mov_b32 v112, 0
  v_mov_b32 v113, 0
  v_mov_b32 v114, 0
  v_mov_b32 v115, 0
  v_mov_b32 v116, 0
  v_mov_b32 v117, 0
  v_mov_b32 v118, 0
  v_mov_b32 v119, 0
  v_mov_b32 v120, 0
  v_mov_b32 v121, 0
  v_mov_b32 v122, 0
  v_mov_b32 v123, 0
  v_mov_b32 v124, 0
  v_mov_b32 v125, 0
  v_mov_b32 v126, 0
  v_mov_b32 v127, 0
  v_mov_b32 v128, 0
  v_mov_b32 v129, 0
  v_mov_b32 v130, 0
  v_mov_b32 v131, 0
  v_mov_b32 v132, 0
  v_mov_b32 v133, 0
  v_mov_b32 v134, 0
  v_mov_b32 v135, 0
  v_mov_b32 v136, 0
  v_mov_b32 v137, 0
  v_mov_b32 v138, 0
  v_mov_b32 v139, 0
  v_mov_b32 v140, 0
  v_mov_b32 v141, 0
  v_mov_b32 v142, 0
  v_mov_b32 v143, 0
  v_mov_b32 v144, 0
  v_mov_b32 v145, 0
  v_mov_b32 v146, 0
  v_mov_b32 v147, 0
  v_mov_b32 v148, 0
  v_mov_b32 v149, 0
  v_mov_b32 v150, 0
  v_mov_b32 v151, 0
  v_mov_b32 v152, 0
  v_mov_b32 v153, 0
  v_mov_b32 v154, 0
  v_mov_b32 v155, 0
  v_mov_b32 v156, 0
  v_mov_b32 v157, 0
  v_mov_b32 v158, 0
  v_mov_b32 v159, 0
  v_mov_b32 v160, 0
  v_mov_b32 v161, 0
  v_mov_b32 v162, 0
  v_mov_b32 v163, 0
  v_mov_b32 v164, 0
  v_mov_b32 v165, 0
  v_mov_b32 v166, 0
  v_mov_b32 v167, 0
  v_mov_b32 v168, 0
  v_mov_b32 v169, 0
  v_mov_b32 v170, 0
  v_mov_b32 v171, 0
  v_mov_b32 v172, 0
  v_mov_b32 v173, 0
  v_mov_b32 v174, 0
  v_mov_b32 v175, 0
  v_mov_b32 v176, 0
  v_mov_b32 v177, 0
  v_mov_b32 v178, 0
  v_mov_b32 v179, 0
  v_mov_b32 v180, 0
  v_mov_b32 v181, 0
  v_mov_b32 v182, 0
  v_mov_b32 v183, 0
  v_mov_b32 v184, 0
  v_mov_b32 v185, 0
  v_mov_b32 v186, 0
  v_mov_b32 v187, 0
  v_mov_b32 v188, 0
  v_mov_b32 v189, 0
  v_mov_b32 v190, 0
  v_mov_b32 v191, 0
  v_mov_b32 v192, 0
  v_mov_b32 v193, 0
  v_mov_b32 v194, 0
  v_mov_b32 v195, 0
  v_mov_b32 v196, 0
  v_mov_b32 v197, 0
  v_mov_b32 v198, 0
  v_mov_b32 v199, 0
  v_mov_b32 v200, 0
  v_mov_b32 v201, 0
  v_mov_b32 v202, 0
  v_mov_b32 v203, 0
  v_mov_b32 v204, 0
  v_mov_b32 v205, 0
  v_mov_b32 v206, 0
  v_mov_b32 v207, 0
  v_mov_b32 v208, 0
  v_mov_b32 v209, 0
  v_mov_b32 v210, 0
  v_mov_b32 v211, 0
  s_mul_i32 s45, s28, 52
  s_lshr_b32 s45, s45, 8
  s_mul_i32 s41, s45, 5
  s_sub_u32 s41, s28, s41
  s_lshl_b32 s41, s41, 7
  s_lshl_b32 s42, s33, 6
  s_add_u32 s41, s41, s42
  s_cmp_eq_u32 s45, 0
  s_cselect_b32 s42, 0, 1
  s_cselect_b32 s43, 0, 5242880
  s_lshl_b32 s48, 1280, s42
  s_lshl_b32 s47, s48, 6
  s_lshl_b32 s40, s27, 2
  s_lshl_b32 s42, s29, 1
  s_add_u32 s40, s40, s42
  s_mul_i32 s42, s40, s48
  s_add_u32 s46, s42, s43
  s_cmp_eq_u32 s45, 2
  s_cbranch_scc1 L_p1_adV
  v_lshrrev_b32 v6, 3, v11
  v_lshlrev_b32 v13, 7, v6
  v_bfe_u32 v6, v11, 1, 1
  v_lshl_or_b32 v13, v6, 6, v13
  v_bfe_u32 v6, v11, 2, 1
  v_lshl_or_b32 v13, v6, 5, v13
  v_and_b32 v6, 1, v11
  v_lshl_or_b32 v13, v6, 4, v13
  s_lshr_b32 s41, s41, 2
  v_add_u32 v6, s41, v12
  v_mul_u32_u24 v7, 52429, v6
  v_lshrrev_b32 v7, 18, v7
  v_mul_u32_u24 v8, 5, v7
  v_sub_u32 v8, v6, v8
  v_mul_u32_u24 v7, s47, v7
  v_and_b32 v9, 1, v8
  v_lshlrev_b32 v9, 9, v9
  v_lshrrev_b32 v10, 1, v8
  v_cmp_eq_u32 s[56:57], 4, v8
  v_lshl_add_u32 v9, v10, 8, v9
  v_add_u32 v10, 512, v9
  v_add_u32 v7, v7, v13
  v_cndmask_b32 v9, v9, v10, s[56:57]
  v_add_u32 v29, v7, v9
  v_add_u32 v6, s41, v12
  v_add_u32 v6, 4, v6
  v_mul_u32_u24 v7, 52429, v6
  v_lshrrev_b32 v7, 18, v7
  v_mul_u32_u24 v8, 5, v7
  v_sub_u32 v8, v6, v8
  v_mul_u32_u24 v7, s47, v7
  v_and_b32 v9, 1, v8
  v_lshlrev_b32 v9, 9, v9
  v_lshrrev_b32 v10, 1, v8
  v_cmp_eq_u32 s[56:57], 4, v8
  v_lshl_add_u32 v9, v10, 8, v9
  v_add_u32 v10, 512, v9
  v_add_u32 v7, v7, v13
  v_cndmask_b32 v9, v9, v10, s[56:57]
  v_add_u32 v30, v7, v9
  v_add_u32 v6, s41, v12
  v_add_u32 v6, 8, v6
  v_mul_u32_u24 v7, 52429, v6
  v_lshrrev_b32 v7, 18, v7
  v_mul_u32_u24 v8, 5, v7
  v_sub_u32 v8, v6, v8
  v_mul_u32_u24 v7, s47, v7
  v_and_b32 v9, 1, v8
  v_lshlrev_b32 v9, 9, v9
  v_lshrrev_b32 v10, 1, v8
  v_cmp_eq_u32 s[56:57], 4, v8
  v_lshl_add_u32 v9, v10, 8, v9
  v_add_u32 v10, 512, v9
  v_add_u32 v7, v7, v13
  v_cndmask_b32 v9, v9, v10, s[56:57]
  v_add_u32 v31, v7, v9
  v_add_u32 v6, s41, v12
  v_add_u32 v6, 12, v6
  v_mul_u32_u24 v7, 52429, v6
  v_lshrrev_b32 v7, 18, v7
  v_mul_u32_u24 v8, 5, v7
  v_sub_u32 v8, v6, v8
  v_mul_u32_u24 v7, s47, v7
  v_and_b32 v9, 1, v8
  v_lshlrev_b32 v9, 9, v9
  v_lshrrev_b32 v10, 1, v8
  v_cmp_eq_u32 s[56:57], 4, v8
  v_lshl_add_u32 v9, v10, 8, v9
  v_add_u32 v10, 512, v9
  v_add_u32 v7, v7, v13
  v_cndmask_b32 v9, v9, v10, s[56:57]
  v_add_u32 v32, v7, v9
  s_branch L_p1_adD
L_p1_adV:
  v_add_u32 v6, s41, v11
  v_mul_u32_u24 v7, 52429, v6
  v_lshrrev_b32 v7, 20, v7
  v_mul_u32_u24 v8, 20, v7
  v_sub_u32 v8, v6, v8
  v_mul_u32_u24 v7, 163840, v7
  v_lshl_add_u32 v7, v8, 6, v7
  v_bfe_u32 v8, v8, 2, 2
  v_xor_b32 v8, v8, v12
  v_lshl_add_u32 v7, v8, 4, v7
  v_add_u32 v29, 1280, v7
  v_add_u32 v6, s41, v11
  v_add_u32 v6, 16, v6
  v_mul_u32_u24 v7, 52429, v6
  v_lshrrev_b32 v7, 20, v7
  v_mul_u32_u24 v8, 20, v7
  v_sub_u32 v8, v6, v8
  v_mul_u32_u24 v7, 163840, v7
  v_lshl_add_u32 v7, v8, 6, v7
  v_bfe_u32 v8, v8, 2, 2
  v_xor_b32 v8, v8, v12
  v_lshl_add_u32 v7, v8, 4, v7
  v_add_u32 v30, 1280, v7
  v_add_u32 v6, s41, v11
  v_add_u32 v6, 32, v6
  v_mul_u32_u24 v7, 52429, v6
  v_lshrrev_b32 v7, 20, v7
  v_mul_u32_u24 v8, 20, v7
  v_sub_u32 v8, v6, v8
  v_mul_u32_u24 v7, 163840, v7
  v_lshl_add_u32 v7, v8, 6, v7
  v_bfe_u32 v8, v8, 2, 2
  v_xor_b32 v8, v8, v12
  v_lshl_add_u32 v7, v8, 4, v7
  v_add_u32 v31, 1280, v7
  v_add_u32 v6, s41, v11
  v_add_u32 v6, 48, v6
  v_mul_u32_u24 v7, 52429, v6
  v_lshrrev_b32 v7, 20, v7
  v_mul_u32_u24 v8, 20, v7
  v_sub_u32 v8, v6, v8
  v_mul_u32_u24 v7, 163840, v7
  v_lshl_add_u32 v7, v8, 6, v7
  v_bfe_u32 v8, v8, 2, 2
  v_xor_b32 v8, v8, v12
  v_lshl_add_u32 v7, v8, 4, v7
  v_add_u32 v32, 1280, v7
L_p1_adD:
  s_waitcnt lgkmcnt(0)
  s_mov_b32 s12, s100
  s_and_b32 s13, s101, 0xffff
  s_mov_b32 s14, 15728640
  s_mov_b32 s15, 0x20000
  s_and_b32 s52, s96, 7
  s_lshr_b32 s53, s96, 3
  s_lshl_b32 s50, s52, 2
  s_lshr_b32 s52, s53, 3
  s_add_u32 s50, s50, s52
  s_and_b32 s51, s53, 7
  s_lshl_b32 s50, s50, 6
  s_lshl_b32 s51, s51, 3
  s_add_u32 s50, s50, s51
  s_and_b32 s51, s97, 3
  s_lshl_b32 s51, s51, 1
  s_add_u32 s50, s50, s51
  s_mul_i32 s50, s50, 1280
  s_add_u32 s50, s50, 2621440
  s_add_u32 s51, s50, 1280
  s_mov_b32 s52, s100
  s_and_b32 s53, s101, 0xffff
  s_mov_b32 s54, 15728640
  s_mov_b32 s55, 0x20000
  v_and_b32 v5, 31, v1
  v_lshlrev_b32 v5, 3, v5
  v_lshrrev_b32 v4, 5, v1
  v_mul_u32_u24 v33, 1280, v4
  v_lshl_add_u32 v4, v4, 8, v5
  v_add3_u32 v5, v5, v33, 0
  v_add_u32 v5, 1024, v5
  s_cmp_eq_u32 s45, 2
  s_cbranch_scc1 L_p1_v1
L_p1_v0:
  s_barrier
  s_mov_b32 s35, 0
  ds_read_b64_tr_b16 v[36:37], v19 offset:0
  ds_read_b64_tr_b16 v[38:39], v19 offset:1024
  ds_read_b64_tr_b16 v[40:41], v20 offset:0
  ds_read_b64_tr_b16 v[42:43], v20 offset:1024
  ds_read_b64_tr_b16 v[44:45], v21 offset:0
  ds_read_b64_tr_b16 v[46:47], v21 offset:1024
  ds_read_b64_tr_b16 v[48:49], v22 offset:0
  ds_read_b64_tr_b16 v[50:51], v22 offset:1024
  ds_read_b128 v[68:71], v23 offset:0
  ds_read_b128 v[72:75], v23 offset:2048
  ds_read_b128 v[76:79], v23 offset:4096
  s_mov_b32 s36, 10
L_p1_loop0_0:
  s_waitcnt lgkmcnt(2)
  v_mfma_f32_16x16x32_bf16 v[84:87], v[36:39], v[68:71], v[84:87]
  ds_read_b128 v[80:83], v23 offset:6144
  ds_read_b64_tr_b16 v[52:53], v19 offset:8192
  v_mfma_f32_16x16x32_bf16 v[100:103], v[40:43], v[68:71], v[100:103]
  ds_read_b64_tr_b16 v[54:55], v19 offset:9216
  v_mfma_f32_16x16x32_bf16 v[116:119], v[44:47], v[68:71], v[116:119]
  ds_read_b64_tr_b16 v[56:57], v20 offset:8192
  v_mfma_f32_16x16x32_bf16 v[132:135], v[48:51], v[68:71], v[132:135]
  ds_read_b64_tr_b16 v[58:59], v20 offset:9216
  v_add_u32 v3, v23, v2
  s_waitcnt lgkmcnt(6)
  v_mfma_f32_16x16x32_bf16 v[88:91], v[36:39], v[72:75], v[88:91]
  ds_read_b128 v[68:71], v3 offset:0
  ds_read_b64_tr_b16 v[60:61], v21 offset:8192
  v_mfma_f32_16x16x32_bf16 v[104:107], v[40:43], v[72:75], v[104:107]
  ds_read_b64_tr_b16 v[62:63], v21 offset:9216
  v_mfma_f32_16x16x32_bf16 v[120:123], v[44:47], v[72:75], v[120:123]
  ds_read_b64_tr_b16 v[64:65], v22 offset:8192
  v_mfma_f32_16x16x32_bf16 v[136:139], v[48:51], v[72:75], v[136:139]
  ds_read_b64_tr_b16 v[66:67], v22 offset:9216
  s_barrier
  s_waitcnt lgkmcnt(10)
  v_mfma_f32_16x16x32_bf16 v[92:95], v[36:39], v[76:79], v[92:95]
  ds_read_b128 v[72:75], v3 offset:2048
  s_add_u32 s35, s35, 1
  v_mfma_f32_16x16x32_bf16 v[108:111], v[40:43], v[76:79], v[108:111]
  s_and_b32 s35, s35, 3
  s_lshl_b32 s30, s35, 15
  v_mfma_f32_16x16x32_bf16 v[124:127], v[44:47], v[76:79], v[124:127]
  s_lshr_b32 s44, s35, 1
  v_mfma_f32_16x16x32_bf16 v[140:143], v[48:51], v[76:79], v[140:143]
  s_lshl_b32 s44, s44, 14
  s_add_u32 s30, s30, s44
  s_add_u32 s30, s30, 16384
  s_waitcnt lgkmcnt(10)
  v_mfma_f32_16x16x32_bf16 v[96:99], v[36:39], v[80:83], v[96:99]
  ds_read_b128 v[76:79], v3 offset:4096
  v_add_u32 v24, s30, v14
  v_mfma_f32_16x16x32_bf16 v[112:115], v[40:43], v[80:83], v[112:115]
  v_add_u32 v25, s30, v15
  v_mfma_f32_16x16x32_bf16 v[128:131], v[44:47], v[80:83], v[128:131]
  v_add_u32 v26, s30, v16
  v_mfma_f32_16x16x32_bf16 v[144:147], v[48:51], v[80:83], v[144:147]
  v_add_u32 v27, s30, v17
  v_add_u32 v28, s30, v18
  s_waitcnt lgkmcnt(2)
  v_mfma_f32_16x16x32_bf16 v[84:87], v[52:55], v[68:71], v[84:87]
  ds_read_b128 v[80:83], v3 offset:6144
  ds_read_b64_tr_b16 v[36:37], v24 offset:0
  v_mfma_f32_16x16x32_bf16 v[100:103], v[56:59], v[68:71], v[100:103]
  ds_read_b64_tr_b16 v[38:39], v24 offset:1024
  v_mfma_f32_16x16x32_bf16 v[116:119], v[60:63], v[68:71], v[116:119]
  ds_read_b64_tr_b16 v[40:41], v25 offset:0
  v_mfma_f32_16x16x32_bf16 v[132:135], v[64:67], v[68:71], v[132:135]
  ds_read_b64_tr_b16 v[42:43], v25 offset:1024
  s_waitcnt lgkmcnt(6)
  v_mfma_f32_16x16x32_bf16 v[88:91], v[52:55], v[72:75], v[88:91]
  ds_read_b128 v[68:71], v28 offset:0
  ds_read_b64_tr_b16 v[44:45], v26 offset:0
  v_mfma_f32_16x16x32_bf16 v[104:107], v[56:59], v[72:75], v[104:107]
  ds_read_b64_tr_b16 v[46:47], v26 offset:1024
  v_mfma_f32_16x16x32_bf16 v[120:123], v[60:63], v[72:75], v[120:123]
  ds_read_b64_tr_b16 v[48:49], v27 offset:0
  v_mfma_f32_16x16x32_bf16 v[136:139], v[64:67], v[72:75], v[136:139]
  ds_read_b64_tr_b16 v[50:51], v27 offset:1024
  s_waitcnt lgkmcnt(10)
  v_mfma_f32_16x16x32_bf16 v[92:95], v[52:55], v[76:79], v[92:95]
  ds_read_b128 v[72:75], v28 offset:2048
  v_mfma_f32_16x16x32_bf16 v[108:111], v[56:59], v[76:79], v[108:111]
  v_mfma_f32_16x16x32_bf16 v[124:127], v[60:63], v[76:79], v[124:127]
  v_mfma_f32_16x16x32_bf16 v[140:143], v[64:67], v[76:79], v[140:143]
  s_waitcnt lgkmcnt(10)
  v_mfma_f32_16x16x32_bf16 v[96:99], v[52:55], v[80:83], v[96:99]
  ds_read_b128 v[76:79], v28 offset:4096
  v_mov_b32 v19, v24
  v_mfma_f32_16x16x32_bf16 v[112:115], v[56:59], v[80:83], v[112:115]
  v_mov_b32 v20, v25
  v_mfma_f32_16x16x32_bf16 v[128:131], v[60:63], v[80:83], v[128:131]
  v_mov_b32 v21, v26
  v_mfma_f32_16x16x32_bf16 v[144:147], v[64:67], v[80:83], v[144:147]
  v_mov_b32 v22, v27
  v_mov_b32 v23, v28
  s_sub_u32 s36, s36, 1
  s_cmp_lg_u32 s36, 0
  s_cbranch_scc1 L_p1_loop0_0
  s_nop 7
  s_cmp_lg_u32 s45, 0
  s_cbranch_scc1 L_p1_ns0
  s_mov_b32 s42, 0x3ea52b5c
  v_mul_f32 v84, s42, v84
  v_mul_f32 v85, s42, v85
  v_mul_f32 v86, s42, v86
  v_mul_f32 v87, s42, v87
  v_mul_f32 v88, s42, v88
  v_mul_f32 v89, s42, v89
  v_mul_f32 v90, s42, v90
  v_mul_f32 v91, s42, v91
  v_mul_f32 v92, s42, v92
  v_mul_f32 v93, s42, v93
  v_mul_f32 v94, s42, v94
  v_mul_f32 v95, s42, v95
  v_mul_f32 v96, s42, v96
  v_mul_f32 v97, s42, v97
  v_mul_f32 v98, s42, v98
  v_mul_f32 v99, s42, v99
  v_mul_f32 v100, s42, v100
  v_mul_f32 v101, s42, v101
  v_mul_f32 v102, s42, v102
  v_mul_f32 v103, s42, v103
  v_mul_f32 v104, s42, v104
  v_mul_f32 v105, s42, v105
  v_mul_f32 v106, s42, v106
  v_mul_f32 v107, s42, v107
  v_mul_f32 v108, s42, v108
  v_mul_f32 v109, s42, v109
  v_mul_f32 v110, s42, v110
  v_mul_f32 v111, s42, v111
  v_mul_f32 v112, s42, v112
  v_mul_f32 v113, s42, v113
  v_mul_f32 v114, s42, v114
  v_mul_f32 v115, s42, v115
  v_mul_f32 v116, s42, v116
  v_mul_f32 v117, s42, v117
  v_mul_f32 v118, s42, v118
  v_mul_f32 v119, s42, v119
  v_mul_f32 v120, s42, v120
  v_mul_f32 v121, s42, v121
  v_mul_f32 v122, s42, v122
  v_mul_f32 v123, s42, v123
  v_mul_f32 v124, s42, v124
  v_mul_f32 v125, s42, v125
  v_mul_f32 v126, s42, v126
  v_mul_f32 v127, s42, v127
  v_mul_f32 v128, s42, v128
  v_mul_f32 v129, s42, v129
  v_mul_f32 v130, s42, v130
  v_mul_f32 v131, s42, v131
  v_mul_f32 v132, s42, v132
  v_mul_f32 v133, s42, v133
  v_mul_f32 v134, s42, v134
  v_mul_f32 v135, s42, v135
  v_mul_f32 v136, s42, v136
  v_mul_f32 v137, s42, v137
  v_mul_f32 v138, s42, v138
  v_mul_f32 v139, s42, v139
  v_mul_f32 v140, s42, v140
  v_mul_f32 v141, s42, v141
  v_mul_f32 v142, s42, v142
  v_mul_f32 v143, s42, v143
  v_mul_f32 v144, s42, v144
  v_mul_f32 v145, s42, v145
  v_mul_f32 v146, s42, v146
  v_mul_f32 v147, s42, v147
L_p1_ns0:
  s_lshl_b32 s41, s48, 11
  s_mul_i32 s41, s41, 1
  s_add_u32 s41, s41, s46
  v_cvt_pk_bf16_f32 v84, v84, v85
  v_cvt_pk_bf16_f32 v85, v86, v87
  v_cvt_pk_bf16_f32 v86, v88, v89
  v_cvt_pk_bf16_f32 v87, v90, v91
  buffer_store_dwordx4 v[84:87], v29, s[12:15], s41 offen sc1
  v_cvt_pk_bf16_f32 v100, v100, v101
  v_cvt_pk_bf16_f32 v101, v102, v103
  v_cvt_pk_bf16_f32 v102, v104, v105
  v_cvt_pk_bf16_f32 v103, v106, v107
  buffer_store_dwordx4 v[100:103], v30, s[12:15], s41 offen sc1
  v_cvt_pk_bf16_f32 v116, v116, v117
  v_cvt_pk_bf16_f32 v117, v118, v119
  v_cvt_pk_bf16_f32 v118, v120, v121
  v_cvt_pk_bf16_f32 v119, v122, v123
  buffer_store_dwordx4 v[116:119], v31, s[12:15], s41 offen sc1
  v_cvt_pk_bf16_f32 v132, v132, v133
  v_cvt_pk_bf16_f32 v133, v134, v135
  v_cvt_pk_bf16_f32 v134, v136, v137
  v_cvt_pk_bf16_f32 v135, v138, v139
  buffer_store_dwordx4 v[132:135], v32, s[12:15], s41 offen sc1
  s_add_u32 s41, s41, s48
  v_cvt_pk_bf16_f32 v92, v92, v93
  v_cvt_pk_bf16_f32 v93, v94, v95
  v_cvt_pk_bf16_f32 v94, v96, v97
  v_cvt_pk_bf16_f32 v95, v98, v99
  buffer_store_dwordx4 v[92:95], v29, s[12:15], s41 offen sc1
  v_cvt_pk_bf16_f32 v108, v108, v109
  v_cvt_pk_bf16_f32 v109, v110, v111
  v_cvt_pk_bf16_f32 v110, v112, v113
  v_cvt_pk_bf16_f32 v111, v114, v115
  buffer_store_dwordx4 v[108:111], v30, s[12:15], s41 offen sc1
  v_cvt_pk_bf16_f32 v124, v124, v125
  v_cvt_pk_bf16_f32 v125, v126, v127
  v_cvt_pk_bf16_f32 v126, v128, v129
  v_cvt_pk_bf16_f32 v127, v130, v131
  buffer_store_dwordx4 v[124:127], v31, s[12:15], s41 offen sc1
  v_cvt_pk_bf16_f32 v140, v140, v141
  v_cvt_pk_bf16_f32 v141, v142, v143
  v_cvt_pk_bf16_f32 v142, v144, v145
  v_cvt_pk_bf16_f32 v143, v146, v147
  buffer_store_dwordx4 v[140:143], v32, s[12:15], s41 offen sc1
  s_nop 1
  v_mov_b32 v96, 0
  v_mov_b32 v97, 0
  v_mov_b32 v98, 0
  v_mov_b32 v99, 0
  v_mov_b32 v100, 0
  v_mov_b32 v101, 0
  v_mov_b32 v102, 0
  v_mov_b32 v103, 0
  v_mov_b32 v104, 0
  v_mov_b32 v105, 0
  v_mov_b32 v106, 0
  v_mov_b32 v107, 0
  v_mov_b32 v108, 0
  v_mov_b32 v109, 0
  v_mov_b32 v110, 0
  v_mov_b32 v111, 0
  v_mov_b32 v112, 0
  v_mov_b32 v113, 0
  v_mov_b32 v114, 0
  v_mov_b32 v115, 0
  v_mov_b32 v116, 0
  v_mov_b32 v117, 0
  v_mov_b32 v118, 0
  v_mov_b32 v119, 0
  v_mov_b32 v120, 0
  v_mov_b32 v121, 0
  v_mov_b32 v122, 0
  v_mov_b32 v123, 0
  v_mov_b32 v124, 0
  v_mov_b32 v125, 0
  v_mov_b32 v126, 0
  v_mov_b32 v127, 0
  s_mov_b32 s36, 10
L_p1_loop0_1:
  s_waitcnt lgkmcnt(2)
  v_mfma_f32_16x16x32_bf16 v[148:151], v[36:39], v[68:71], v[148:151]
  ds_read_b128 v[80:83], v23 offset:6144
  ds_read_b64_tr_b16 v[52:53], v19 offset:8192
  v_mfma_f32_16x16x32_bf16 v[164:167], v[40:43], v[68:71], v[164:167]
  ds_read_b64_tr_b16 v[54:55], v19 offset:9216
  v_mfma_f32_16x16x32_bf16 v[180:183], v[44:47], v[68:71], v[180:183]
  ds_read_b64_tr_b16 v[56:57], v20 offset:8192
  v_mfma_f32_16x16x32_bf16 v[196:199], v[48:51], v[68:71], v[196:199]
  ds_read_b64_tr_b16 v[58:59], v20 offset:9216
  v_add_u32 v3, v23, v2
  s_waitcnt lgkmcnt(6)
  v_mfma_f32_16x16x32_bf16 v[152:155], v[36:39], v[72:75], v[152:155]
  ds_read_b128 v[68:71], v3 offset:0
  ds_read_b64_tr_b16 v[60:61], v21 offset:8192
  v_mfma_f32_16x16x32_bf16 v[168:171], v[40:43], v[72:75], v[168:171]
  ds_read_b64_tr_b16 v[62:63], v21 offset:9216
  v_mfma_f32_16x16x32_bf16 v[184:187], v[44:47], v[72:75], v[184:187]
  ds_read_b64_tr_b16 v[64:65], v22 offset:8192
  v_mfma_f32_16x16x32_bf16 v[200:203], v[48:51], v[72:75], v[200:203]
  ds_read_b64_tr_b16 v[66:67], v22 offset:9216
  s_cmp_eq_u32 s36, 9
  s_cbranch_scc0 L_p1_nw0
  s_waitcnt vmcnt(0)
L_p1_nw0:
  s_barrier
  s_waitcnt lgkmcnt(10)
  v_mfma_f32_16x16x32_bf16 v[156:159], v[36:39], v[76:79], v[156:159]
  ds_read_b128 v[72:75], v3 offset:2048
  s_add_u32 s35, s35, 1
  v_mfma_f32_16x16x32_bf16 v[172:175], v[40:43], v[76:79], v[172:175]
  s_and_b32 s35, s35, 3
  s_lshl_b32 s30, s35, 15
  v_mfma_f32_16x16x32_bf16 v[188:191], v[44:47], v[76:79], v[188:191]
  s_lshr_b32 s44, s35, 1
  v_mfma_f32_16x16x32_bf16 v[204:207], v[48:51], v[76:79], v[204:207]
  s_lshl_b32 s44, s44, 14
  s_add_u32 s30, s30, s44
  s_add_u32 s30, s30, 16384
  s_waitcnt lgkmcnt(10)
  v_mfma_f32_16x16x32_bf16 v[160:163], v[36:39], v[80:83], v[160:163]
  ds_read_b128 v[76:79], v3 offset:4096
  v_add_u32 v24, s30, v14
  v_mfma_f32_16x16x32_bf16 v[176:179], v[40:43], v[80:83], v[176:179]
  v_add_u32 v25, s30, v15
  v_mfma_f32_16x16x32_bf16 v[192:195], v[44:47], v[80:83], v[192:195]
  v_add_u32 v26, s30, v16
  v_mfma_f32_16x16x32_bf16 v[208:211], v[48:51], v[80:83], v[208:211]
  v_add_u32 v27, s30, v17
  v_add_u32 v28, s30, v18
  s_waitcnt lgkmcnt(2)
  v_mfma_f32_16x16x32_bf16 v[148:151], v[52:55], v[68:71], v[148:151]
  ds_read_b128 v[80:83], v3 offset:6144
  ds_read_b64_tr_b16 v[36:37], v24 offset:0
  v_mfma_f32_16x16x32_bf16 v[164:167], v[56:59], v[68:71], v[164:167]
  ds_read_b64_tr_b16 v[38:39], v24 offset:1024
  v_mfma_f32_16x16x32_bf16 v[180:183], v[60:63], v[68:71], v[180:183]
  ds_read_b64_tr_b16 v[40:41], v25 offset:0
  v_mfma_f32_16x16x32_bf16 v[196:199], v[64:67], v[68:71], v[196:199]
  ds_read_b64_tr_b16 v[42:43], v25 offset:1024
  s_waitcnt lgkmcnt(6)
  v_mfma_f32_16x16x32_bf16 v[152:155], v[52:55], v[72:75], v[152:155]
  ds_read_b128 v[68:71], v28 offset:0
  ds_read_b64_tr_b16 v[44:45], v26 offset:0
  v_mfma_f32_16x16x32_bf16 v[168:171], v[56:59], v[72:75], v[168:171]
  ds_read_b64_tr_b16 v[46:47], v26 offset:1024
  v_mfma_f32_16x16x32_bf16 v[184:187], v[60:63], v[72:75], v[184:187]
  ds_read_b64_tr_b16 v[48:49], v27 offset:0
  v_mfma_f32_16x16x32_bf16 v[200:203], v[64:67], v[72:75], v[200:203]
  ds_read_b64_tr_b16 v[50:51], v27 offset:1024
  s_waitcnt lgkmcnt(10)
  v_mfma_f32_16x16x32_bf16 v[156:159], v[52:55], v[76:79], v[156:159]
  ds_read_b128 v[72:75], v28 offset:2048
  v_mfma_f32_16x16x32_bf16 v[172:175], v[56:59], v[76:79], v[172:175]
  v_mfma_f32_16x16x32_bf16 v[188:191], v[60:63], v[76:79], v[188:191]
  v_mfma_f32_16x16x32_bf16 v[204:207], v[64:67], v[76:79], v[204:207]
  s_waitcnt lgkmcnt(10)
  v_mfma_f32_16x16x32_bf16 v[160:163], v[52:55], v[80:83], v[160:163]
  ds_read_b128 v[76:79], v28 offset:4096
  v_mov_b32 v19, v24
  v_mfma_f32_16x16x32_bf16 v[176:179], v[56:59], v[80:83], v[176:179]
  v_mov_b32 v20, v25
  v_mfma_f32_16x16x32_bf16 v[192:195], v[60:63], v[80:83], v[192:195]
  v_mov_b32 v21, v26
  v_mfma_f32_16x16x32_bf16 v[208:211], v[64:67], v[80:83], v[208:211]
  v_mov_b32 v22, v27
  v_mov_b32 v23, v28
  s_sub_u32 s36, s36, 1
  s_cmp_lg_u32 s36, 0
  s_cbranch_scc1 L_p1_loop0_1
  s_nop 7
  s_waitcnt lgkmcnt(0)
  buffer_load_dwordx2 v[16:17], v4, s[52:55], s50 offen
  buffer_load_dwordx2 v[18:19], v4, s[52:55], s50 offen offset:512
  buffer_load_dwordx2 v[24:25], v4, s[52:55], s51 offen
  buffer_load_dwordx2 v[26:27], v4, s[52:55], s51 offen offset:512
  buffer_load_dwordx2 v[20:21], v5, s[52:55], s50 offen
  s_cmp_lg_u32 s45, 0
  s_cbranch_scc1 L_p1_ns1
  s_mov_b32 s42, 0x3ea52b5c
  v_mul_f32 v148, s42, v148
  v_mul_f32 v149, s42, v149
  v_mul_f32 v150, s42, v150
  v_mul_f32 v151, s42, v151
  v_mul_f32 v152, s42, v152
  v_mul_f32 v153, s42, v153
  v_mul_f32 v154, s42, v154
  v_mul_f32 v155, s42, v155
  v_mul_f32 v156, s42, v156
  v_mul_f32 v157, s42, v157
  v_mul_f32 v158, s42, v158
  v_mul_f32 v159, s42, v159
  v_mul_f32 v160, s42, v160
  v_mul_f32 v161, s42, v161
  v_mul_f32 v162, s42, v162
  v_mul_f32 v163, s42, v163
  v_mul_f32 v164, s42, v164
  v_mul_f32 v165, s42, v165
  v_mul_f32 v166, s42, v166
  v_mul_f32 v167, s42, v167
  v_mul_f32 v168, s42, v168
  v_mul_f32 v169, s42, v169
  v_mul_f32 v170, s42, v170
  v_mul_f32 v171, s42, v171
  v_mul_f32 v172, s42, v172
  v_mul_f32 v173, s42, v173
  v_mul_f32 v174, s42, v174
  v_mul_f32 v175, s42, v175
  v_mul_f32 v176, s42, v176
  v_mul_f32 v177, s42, v177
  v_mul_f32 v178, s42, v178
  v_mul_f32 v179, s42, v179
  v_mul_f32 v180, s42, v180
  v_mul_f32 v181, s42, v181
  v_mul_f32 v182, s42, v182
  v_mul_f32 v183, s42, v183
  v_mul_f32 v184, s42, v184
  v_mul_f32 v185, s42, v185
  v_mul_f32 v186, s42, v186
  v_mul_f32 v187, s42, v187
  v_mul_f32 v188, s42, v188
  v_mul_f32 v189, s42, v189
  v_mul_f32 v190, s42, v190
  v_mul_f32 v191, s42, v191
  v_mul_f32 v192, s42, v192
  v_mul_f32 v193, s42, v193
  v_mul_f32 v194, s42, v194
  v_mul_f32 v195, s42, v195
  v_mul_f32 v196, s42, v196
  v_mul_f32 v197, s42, v197
  v_mul_f32 v198, s42, v198
  v_mul_f32 v199, s42, v199
  v_mul_f32 v200, s42, v200
  v_mul_f32 v201, s42, v201
  v_mul_f32 v202, s42, v202
  v_mul_f32 v203, s42, v203
  v_mul_f32 v204, s42, v204
  v_mul_f32 v205, s42, v205
  v_mul_f32 v206, s42, v206
  v_mul_f32 v207, s42, v207
  v_mul_f32 v208, s42, v208
  v_mul_f32 v209, s42, v209
  v_mul_f32 v210, s42, v210
  v_mul_f32 v211, s42, v211
L_p1_ns1:
  s_lshl_b32 s41, s48, 11
  s_mul_i32 s41, s41, 0
  s_add_u32 s41, s41, s46
  v_cvt_pk_bf16_f32 v148, v148, v149
  v_cvt_pk_bf16_f32 v149, v150, v151
  v_cvt_pk_bf16_f32 v150, v152, v153
  v_cvt_pk_bf16_f32 v151, v154, v155
  buffer_store_dwordx4 v[148:151], v29, s[12:15], s41 offen sc1
  v_cvt_pk_bf16_f32 v164, v164, v165
  v_cvt_pk_bf16_f32 v165, v166, v167
  v_cvt_pk_bf16_f32 v166, v168, v169
  v_cvt_pk_bf16_f32 v167, v170, v171
  buffer_store_dwordx4 v[164:167], v30, s[12:15], s41 offen sc1
  v_cvt_pk_bf16_f32 v180, v180, v181
  v_cvt_pk_bf16_f32 v181, v182, v183
  v_cvt_pk_bf16_f32 v182, v184, v185
  v_cvt_pk_bf16_f32 v183, v186, v187
  buffer_store_dwordx4 v[180:183], v31, s[12:15], s41 offen sc1
  v_cvt_pk_bf16_f32 v196, v196, v197
  v_cvt_pk_bf16_f32 v197, v198, v199
  v_cvt_pk_bf16_f32 v198, v200, v201
  v_cvt_pk_bf16_f32 v199, v202, v203
  buffer_store_dwordx4 v[196:199], v32, s[12:15], s41 offen sc1
  s_add_u32 s41, s41, s48
  v_cvt_pk_bf16_f32 v156, v156, v157
  v_cvt_pk_bf16_f32 v157, v158, v159
  v_cvt_pk_bf16_f32 v158, v160, v161
  v_cvt_pk_bf16_f32 v159, v162, v163
  buffer_store_dwordx4 v[156:159], v29, s[12:15], s41 offen sc1
  v_cvt_pk_bf16_f32 v172, v172, v173
  v_cvt_pk_bf16_f32 v173, v174, v175
  v_cvt_pk_bf16_f32 v174, v176, v177
  v_cvt_pk_bf16_f32 v175, v178, v179
  buffer_store_dwordx4 v[172:175], v30, s[12:15], s41 offen sc1
  v_cvt_pk_bf16_f32 v188, v188, v189
  v_cvt_pk_bf16_f32 v189, v190, v191
  v_cvt_pk_bf16_f32 v190, v192, v193
  v_cvt_pk_bf16_f32 v191, v194, v195
  buffer_store_dwordx4 v[188:191], v31, s[12:15], s41 offen sc1
  v_cvt_pk_bf16_f32 v204, v204, v205
  v_cvt_pk_bf16_f32 v205, v206, v207
  v_cvt_pk_bf16_f32 v206, v208, v209
  v_cvt_pk_bf16_f32 v207, v210, v211
  buffer_store_dwordx4 v[204:207], v32, s[12:15], s41 offen sc1
  s_mov_b32 s49, 8
  s_branch L_p1_done
L_p1_v1:
  s_barrier
  s_mov_b32 s35, 0
  ds_read_b64_tr_b16 v[36:37], v19 offset:0
  ds_read_b64_tr_b16 v[38:39], v19 offset:1024
  ds_read_b64_tr_b16 v[40:41], v20 offset:0
  ds_read_b64_tr_b16 v[42:43], v20 offset:1024
  ds_read_b64_tr_b16 v[44:45], v21 offset:0
  ds_read_b64_tr_b16 v[46:47], v21 offset:1024
  ds_read_b64_tr_b16 v[48:49], v22 offset:0
  ds_read_b64_tr_b16 v[50:51], v22 offset:1024
  ds_read_b128 v[68:71], v23 offset:0
  ds_read_b128 v[72:75], v23 offset:2048
  ds_read_b128 v[76:79], v23 offset:4096
  s_mov_b32 s36, 10
L_p1_loop1_0:
  s_waitcnt lgkmcnt(2)
  v_mfma_f32_16x16x32_bf16 v[84:87], v[68:71], v[36:39], v[84:87]
  ds_read_b128 v[80:83], v23 offset:6144
  ds_read_b64_tr_b16 v[52:53], v19 offset:8192
  v_mfma_f32_16x16x32_bf16 v[100:103], v[68:71], v[40:43], v[100:103]
  ds_read_b64_tr_b16 v[54:55], v19 offset:9216
  v_mfma_f32_16x16x32_bf16 v[116:119], v[68:71], v[44:47], v[116:119]
  ds_read_b64_tr_b16 v[56:57], v20 offset:8192
  v_mfma_f32_16x16x32_bf16 v[132:135], v[68:71], v[48:51], v[132:135]
  ds_read_b64_tr_b16 v[58:59], v20 offset:9216
  v_add_u32 v3, v23, v2
  s_waitcnt lgkmcnt(6)
  v_mfma_f32_16x16x32_bf16 v[88:91], v[72:75], v[36:39], v[88:91]
  ds_read_b128 v[68:71], v3 offset:0
  ds_read_b64_tr_b16 v[60:61], v21 offset:8192
  v_mfma_f32_16x16x32_bf16 v[104:107], v[72:75], v[40:43], v[104:107]
  ds_read_b64_tr_b16 v[62:63], v21 offset:9216
  v_mfma_f32_16x16x32_bf16 v[120:123], v[72:75], v[44:47], v[120:123]
  ds_read_b64_tr_b16 v[64:65], v22 offset:8192
  v_mfma_f32_16x16x32_bf16 v[136:139], v[72:75], v[48:51], v[136:139]
  ds_read_b64_tr_b16 v[66:67], v22 offset:9216
  s_barrier
  s_waitcnt lgkmcnt(10)
  v_mfma_f32_16x16x32_bf16 v[92:95], v[76:79], v[36:39], v[92:95]
  ds_read_b128 v[72:75], v3 offset:2048
  s_add_u32 s35, s35, 1
  v_mfma_f32_16x16x32_bf16 v[108:111], v[76:79], v[40:43], v[108:111]
  s_and_b32 s35, s35, 3
  s_lshl_b32 s30, s35, 15
  v_mfma_f32_16x16x32_bf16 v[124:127], v[76:79], v[44:47], v[124:127]
  s_lshr_b32 s44, s35, 1
  v_mfma_f32_16x16x32_bf16 v[140:143], v[76:79], v[48:51], v[140:143]
  s_lshl_b32 s44, s44, 14
  s_add_u32 s30, s30, s44
  s_add_u32 s30, s30, 16384
  s_waitcnt lgkmcnt(10)
  v_mfma_f32_16x16x32_bf16 v[96:99], v[80:83], v[36:39], v[96:99]
  ds_read_b128 v[76:79], v3 offset:4096
  v_add_u32 v24, s30, v14
  v_mfma_f32_16x16x32_bf16 v[112:115], v[80:83], v[40:43], v[112:115]
  v_add_u32 v25, s30, v15
  v_mfma_f32_16x16x32_bf16 v[128:131], v[80:83], v[44:47], v[128:131]
  v_add_u32 v26, s30, v16
  v_mfma_f32_16x16x32_bf16 v[144:147], v[80:83], v[48:51], v[144:147]
  v_add_u32 v27, s30, v17
  v_add_u32 v28, s30, v18
  s_waitcnt lgkmcnt(2)
  v_mfma_f32_16x16x32_bf16 v[84:87], v[68:71], v[52:55], v[84:87]
  ds_read_b128 v[80:83], v3 offset:6144
  ds_read_b64_tr_b16 v[36:37], v24 offset:0
  v_mfma_f32_16x16x32_bf16 v[100:103], v[68:71], v[56:59], v[100:103]
  ds_read_b64_tr_b16 v[38:39], v24 offset:1024
  v_mfma_f32_16x16x32_bf16 v[116:119], v[68:71], v[60:63], v[116:119]
  ds_read_b64_tr_b16 v[40:41], v25 offset:0
  v_mfma_f32_16x16x32_bf16 v[132:135], v[68:71], v[64:67], v[132:135]
  ds_read_b64_tr_b16 v[42:43], v25 offset:1024
  s_waitcnt lgkmcnt(6)
  v_mfma_f32_16x16x32_bf16 v[88:91], v[72:75], v[52:55], v[88:91]
  ds_read_b128 v[68:71], v28 offset:0
  ds_read_b64_tr_b16 v[44:45], v26 offset:0
  v_mfma_f32_16x16x32_bf16 v[104:107], v[72:75], v[56:59], v[104:107]
  ds_read_b64_tr_b16 v[46:47], v26 offset:1024
  v_mfma_f32_16x16x32_bf16 v[120:123], v[72:75], v[60:63], v[120:123]
  ds_read_b64_tr_b16 v[48:49], v27 offset:0
  v_mfma_f32_16x16x32_bf16 v[136:139], v[72:75], v[64:67], v[136:139]
  ds_read_b64_tr_b16 v[50:51], v27 offset:1024
  s_waitcnt lgkmcnt(10)
  v_mfma_f32_16x16x32_bf16 v[92:95], v[76:79], v[52:55], v[92:95]
  ds_read_b128 v[72:75], v28 offset:2048
  v_mfma_f32_16x16x32_bf16 v[108:111], v[76:79], v[56:59], v[108:111]
  v_mfma_f32_16x16x32_bf16 v[124:127], v[76:79], v[60:63], v[124:127]
  v_mfma_f32_16x16x32_bf16 v[140:143], v[76:79], v[64:67], v[140:143]
  s_waitcnt lgkmcnt(10)
  v_mfma_f32_16x16x32_bf16 v[96:99], v[80:83], v[52:55], v[96:99]
  ds_read_b128 v[76:79], v28 offset:4096
  v_mov_b32 v19, v24
  v_mfma_f32_16x16x32_bf16 v[112:115], v[80:83], v[56:59], v[112:115]
  v_mov_b32 v20, v25
  v_mfma_f32_16x16x32_bf16 v[128:131], v[80:83], v[60:63], v[128:131]
  v_mov_b32 v21, v26
  v_mfma_f32_16x16x32_bf16 v[144:147], v[80:83], v[64:67], v[144:147]
  v_mov_b32 v22, v27
  v_mov_b32 v23, v28
  s_sub_u32 s36, s36, 1
  s_cmp_lg_u32 s36, 0
  s_cbranch_scc1 L_p1_loop1_0
  s_nop 7
  s_lshl_b32 s41, s48, 11
  s_mul_i32 s41, s41, 1
  s_add_u32 s41, s41, s46
  v_cvt_pk_bf16_f32 v84, v84, v88
  v_cvt_pk_bf16_f32 v85, v85, v89
  v_cvt_pk_bf16_f32 v86, v86, v90
  v_cvt_pk_bf16_f32 v87, v87, v91
  buffer_store_dwordx4 v[84:87], v29, s[12:15], s41 offen sc1
  v_cvt_pk_bf16_f32 v100, v100, v104
  v_cvt_pk_bf16_f32 v101, v101, v105
  v_cvt_pk_bf16_f32 v102, v102, v106
  v_cvt_pk_bf16_f32 v103, v103, v107
  buffer_store_dwordx4 v[100:103], v30, s[12:15], s41 offen sc1
  v_cvt_pk_bf16_f32 v116, v116, v120
  v_cvt_pk_bf16_f32 v117, v117, v121
  v_cvt_pk_bf16_f32 v118, v118, v122
  v_cvt_pk_bf16_f32 v119, v119, v123
  buffer_store_dwordx4 v[116:119], v31, s[12:15], s41 offen sc1
  v_cvt_pk_bf16_f32 v132, v132, v136
  v_cvt_pk_bf16_f32 v133, v133, v137
  v_cvt_pk_bf16_f32 v134, v134, v138
  v_cvt_pk_bf16_f32 v135, v135, v139
  buffer_store_dwordx4 v[132:135], v32, s[12:15], s41 offen sc1
  s_add_u32 s41, s41, s48
  v_cvt_pk_bf16_f32 v92, v92, v96
  v_cvt_pk_bf16_f32 v93, v93, v97
  v_cvt_pk_bf16_f32 v94, v94, v98
  v_cvt_pk_bf16_f32 v95, v95, v99
  buffer_store_dwordx4 v[92:95], v29, s[12:15], s41 offen sc1
  v_cvt_pk_bf16_f32 v108, v108, v112
  v_cvt_pk_bf16_f32 v109, v109, v113
  v_cvt_pk_bf16_f32 v110, v110, v114
  v_cvt_pk_bf16_f32 v111, v111, v115
  buffer_store_dwordx4 v[108:111], v30, s[12:15], s41 offen sc1
  v_cvt_pk_bf16_f32 v124, v124, v128
  v_cvt_pk_bf16_f32 v125, v125, v129
  v_cvt_pk_bf16_f32 v126, v126, v130
  v_cvt_pk_bf16_f32 v127, v127, v131
  buffer_store_dwordx4 v[124:127], v31, s[12:15], s41 offen sc1
  v_cvt_pk_bf16_f32 v140, v140, v144
  v_cvt_pk_bf16_f32 v141, v141, v145
  v_cvt_pk_bf16_f32 v142, v142, v146
  v_cvt_pk_bf16_f32 v143, v143, v147
  buffer_store_dwordx4 v[140:143], v32, s[12:15], s41 offen sc1
  s_nop 1
  v_mov_b32 v96, 0
  v_mov_b32 v97, 0
  v_mov_b32 v98, 0
  v_mov_b32 v99, 0
  v_mov_b32 v100, 0
  v_mov_b32 v101, 0
  v_mov_b32 v102, 0
  v_mov_b32 v103, 0
  v_mov_b32 v104, 0
  v_mov_b32 v105, 0
  v_mov_b32 v106, 0
  v_mov_b32 v107, 0
  v_mov_b32 v108, 0
  v_mov_b32 v109, 0
  v_mov_b32 v110, 0
  v_mov_b32 v111, 0
  v_mov_b32 v112, 0
  v_mov_b32 v113, 0
  v_mov_b32 v114, 0
  v_mov_b32 v115, 0
  v_mov_b32 v116, 0
  v_mov_b32 v117, 0
  v_mov_b32 v118, 0
  v_mov_b32 v119, 0
  v_mov_b32 v120, 0
  v_mov_b32 v121, 0
  v_mov_b32 v122, 0
  v_mov_b32 v123, 0
  v_mov_b32 v124, 0
  v_mov_b32 v125, 0
  v_mov_b32 v126, 0
  v_mov_b32 v127, 0
  s_mov_b32 s36, 10
L_p1_loop1_1:
  s_waitcnt lgkmcnt(2)
  v_mfma_f32_16x16x32_bf16 v[148:151], v[68:71], v[36:39], v[148:151]
  ds_read_b128 v[80:83], v23 offset:6144
  ds_read_b64_tr_b16 v[52:53], v19 offset:8192
  v_mfma_f32_16x16x32_bf16 v[164:167], v[68:71], v[40:43], v[164:167]
  ds_read_b64_tr_b16 v[54:55], v19 offset:9216
  v_mfma_f32_16x16x32_bf16 v[180:183], v[68:71], v[44:47], v[180:183]
  ds_read_b64_tr_b16 v[56:57], v20 offset:8192
  v_mfma_f32_16x16x32_bf16 v[196:199], v[68:71], v[48:51], v[196:199]
  ds_read_b64_tr_b16 v[58:59], v20 offset:9216
  v_add_u32 v3, v23, v2
  s_waitcnt lgkmcnt(6)
  v_mfma_f32_16x16x32_bf16 v[152:155], v[72:75], v[36:39], v[152:155]
  ds_read_b128 v[68:71], v3 offset:0
  ds_read_b64_tr_b16 v[60:61], v21 offset:8192
  v_mfma_f32_16x16x32_bf16 v[168:171], v[72:75], v[40:43], v[168:171]
  ds_read_b64_tr_b16 v[62:63], v21 offset:9216
  v_mfma_f32_16x16x32_bf16 v[184:187], v[72:75], v[44:47], v[184:187]
  ds_read_b64_tr_b16 v[64:65], v22 offset:8192
  v_mfma_f32_16x16x32_bf16 v[200:203], v[72:75], v[48:51], v[200:203]
  ds_read_b64_tr_b16 v[66:67], v22 offset:9216
  s_cmp_eq_u32 s36, 9
  s_cbranch_scc0 L_p1_nw1
  s_waitcnt vmcnt(0)
L_p1_nw1:
  s_barrier
  s_waitcnt lgkmcnt(10)
  v_mfma_f32_16x16x32_bf16 v[156:159], v[76:79], v[36:39], v[156:159]
  ds_read_b128 v[72:75], v3 offset:2048
  s_add_u32 s35, s35, 1
  v_mfma_f32_16x16x32_bf16 v[172:175], v[76:79], v[40:43], v[172:175]
  s_and_b32 s35, s35, 3
  s_lshl_b32 s30, s35, 15
  v_mfma_f32_16x16x32_bf16 v[188:191], v[76:79], v[44:47], v[188:191]
  s_lshr_b32 s44, s35, 1
  v_mfma_f32_16x16x32_bf16 v[204:207], v[76:79], v[48:51], v[204:207]
  s_lshl_b32 s44, s44, 14
  s_add_u32 s30, s30, s44
  s_add_u32 s30, s30, 16384
  s_waitcnt lgkmcnt(10)
  v_mfma_f32_16x16x32_bf16 v[160:163], v[80:83], v[36:39], v[160:163]
  ds_read_b128 v[76:79], v3 offset:4096
  v_add_u32 v24, s30, v14
  v_mfma_f32_16x16x32_bf16 v[176:179], v[80:83], v[40:43], v[176:179]
  v_add_u32 v25, s30, v15
  v_mfma_f32_16x16x32_bf16 v[192:195], v[80:83], v[44:47], v[192:195]
  v_add_u32 v26, s30, v16
  v_mfma_f32_16x16x32_bf16 v[208:211], v[80:83], v[48:51], v[208:211]
  v_add_u32 v27, s30, v17
  v_add_u32 v28, s30, v18
  s_waitcnt lgkmcnt(2)
  v_mfma_f32_16x16x32_bf16 v[148:151], v[68:71], v[52:55], v[148:151]
  ds_read_b128 v[80:83], v3 offset:6144
  ds_read_b64_tr_b16 v[36:37], v24 offset:0
  v_mfma_f32_16x16x32_bf16 v[164:167], v[68:71], v[56:59], v[164:167]
  ds_read_b64_tr_b16 v[38:39], v24 offset:1024
  v_mfma_f32_16x16x32_bf16 v[180:183], v[68:71], v[60:63], v[180:183]
  ds_read_b64_tr_b16 v[40:41], v25 offset:0
  v_mfma_f32_16x16x32_bf16 v[196:199], v[68:71], v[64:67], v[196:199]
  ds_read_b64_tr_b16 v[42:43], v25 offset:1024
  s_waitcnt lgkmcnt(6)
  v_mfma_f32_16x16x32_bf16 v[152:155], v[72:75], v[52:55], v[152:155]
  ds_read_b128 v[68:71], v28 offset:0
  ds_read_b64_tr_b16 v[44:45], v26 offset:0
  v_mfma_f32_16x16x32_bf16 v[168:171], v[72:75], v[56:59], v[168:171]
  ds_read_b64_tr_b16 v[46:47], v26 offset:1024
  v_mfma_f32_16x16x32_bf16 v[184:187], v[72:75], v[60:63], v[184:187]
  ds_read_b64_tr_b16 v[48:49], v27 offset:0
  v_mfma_f32_16x16x32_bf16 v[200:203], v[72:75], v[64:67], v[200:203]
  ds_read_b64_tr_b16 v[50:51], v27 offset:1024
  s_waitcnt lgkmcnt(10)
  v_mfma_f32_16x16x32_bf16 v[156:159], v[76:79], v[52:55], v[156:159]
  ds_read_b128 v[72:75], v28 offset:2048
  v_mfma_f32_16x16x32_bf16 v[172:175], v[76:79], v[56:59], v[172:175]
  v_mfma_f32_16x16x32_bf16 v[188:191], v[76:79], v[60:63], v[188:191]
  v_mfma_f32_16x16x32_bf16 v[204:207], v[76:79], v[64:67], v[204:207]
  s_waitcnt lgkmcnt(10)
  v_mfma_f32_16x16x32_bf16 v[160:163], v[80:83], v[52:55], v[160:163]
  ds_read_b128 v[76:79], v28 offset:4096
  v_mov_b32 v19, v24
  v_mfma_f32_16x16x32_bf16 v[176:179], v[80:83], v[56:59], v[176:179]
  v_mov_b32 v20, v25
  v_mfma_f32_16x16x32_bf16 v[192:195], v[80:83], v[60:63], v[192:195]
  v_mov_b32 v21, v26
  v_mfma_f32_16x16x32_bf16 v[208:211], v[80:83], v[64:67], v[208:211]
  v_mov_b32 v22, v27
  v_mov_b32 v23, v28
  s_sub_u32 s36, s36, 1
  s_cmp_lg_u32 s36, 0
  s_cbranch_scc1 L_p1_loop1_1
  s_nop 7
  s_waitcnt lgkmcnt(0)
  buffer_load_dwordx2 v[16:17], v4, s[52:55], s50 offen
  buffer_load_dwordx2 v[18:19], v4, s[52:55], s50 offen offset:512
  buffer_load_dwordx2 v[24:25], v4, s[52:55], s51 offen
  buffer_load_dwordx2 v[26:27], v4, s[52:55], s51 offen offset:512
  buffer_load_dwordx2 v[20:21], v5, s[52:55], s50 offen
  s_lshl_b32 s41, s48, 11
  s_mul_i32 s41, s41, 0
  s_add_u32 s41, s41, s46
  v_cvt_pk_bf16_f32 v148, v148, v152
  v_cvt_pk_bf16_f32 v149, v149, v153
  v_cvt_pk_bf16_f32 v150, v150, v154
  v_cvt_pk_bf16_f32 v151, v151, v155
  buffer_store_dwordx4 v[148:151], v29, s[12:15], s41 offen sc1
  v_cvt_pk_bf16_f32 v164, v164, v168
  v_cvt_pk_bf16_f32 v165, v165, v169
  v_cvt_pk_bf16_f32 v166, v166, v170
  v_cvt_pk_bf16_f32 v167, v167, v171
  buffer_store_dwordx4 v[164:167], v30, s[12:15], s41 offen sc1
  v_cvt_pk_bf16_f32 v180, v180, v184
  v_cvt_pk_bf16_f32 v181, v181, v185
  v_cvt_pk_bf16_f32 v182, v182, v186
  v_cvt_pk_bf16_f32 v183, v183, v187
  buffer_store_dwordx4 v[180:183], v31, s[12:15], s41 offen sc1
  v_cvt_pk_bf16_f32 v196, v196, v200
  v_cvt_pk_bf16_f32 v197, v197, v201
  v_cvt_pk_bf16_f32 v198, v198, v202
  v_cvt_pk_bf16_f32 v199, v199, v203
  buffer_store_dwordx4 v[196:199], v32, s[12:15], s41 offen sc1
  s_add_u32 s41, s41, s48
  v_cvt_pk_bf16_f32 v156, v156, v160
  v_cvt_pk_bf16_f32 v157, v157, v161
  v_cvt_pk_bf16_f32 v158, v158, v162
  v_cvt_pk_bf16_f32 v159, v159, v163
  buffer_store_dwordx4 v[156:159], v29, s[12:15], s41 offen sc1
  v_cvt_pk_bf16_f32 v172, v172, v176
  v_cvt_pk_bf16_f32 v173, v173, v177
  v_cvt_pk_bf16_f32 v174, v174, v178
  v_cvt_pk_bf16_f32 v175, v175, v179
  buffer_store_dwordx4 v[172:175], v30, s[12:15], s41 offen sc1
  v_cvt_pk_bf16_f32 v188, v188, v192
  v_cvt_pk_bf16_f32 v189, v189, v193
  v_cvt_pk_bf16_f32 v190, v190, v194
  v_cvt_pk_bf16_f32 v191, v191, v195
  buffer_store_dwordx4 v[188:191], v31, s[12:15], s41 offen sc1
  v_cvt_pk_bf16_f32 v204, v204, v208
  v_cvt_pk_bf16_f32 v205, v205, v209
  v_cvt_pk_bf16_f32 v206, v206, v210
  v_cvt_pk_bf16_f32 v207, v207, v211
  buffer_store_dwordx4 v[204:207], v32, s[12:15], s41 offen sc1
  s_mov_b32 s49, 8
  s_branch L_p1_done
L_p1_skip:
  s_and_b32 s52, s96, 7
  s_lshr_b32 s53, s96, 3
  s_lshl_b32 s50, s52, 2
  s_lshr_b32 s52, s53, 3
  s_add_u32 s50, s50, s52
  s_and_b32 s51, s53, 7
  v_lshlrev_b32 v248, 4, v1
  v_and_b32 v249, 31, v1
  v_lshlrev_b32 v3, 3, v249
  v_add_u32 v245, 1024, v3
  v_mov_b32 v4, 0x70000000
  v_cmp_gt_u32 s[56:57], 32, v1
  s_nop 1
  v_cndmask_b32 v253, v4, v245, s[56:57]
  v_lshrrev_b32 v2, 5, v1
  v_lshlrev_b32 v244, 3, v249
  v_lshl_add_u32 v244, v2, 8, v244
  v_mov_b32 v252, v244
  v_bfe_u32 v3, v249, 2, 2
  v_xor_b32 v3, v3, v2
  v_lshlrev_b32 v3, 4, v3
  v_lshl_add_u32 v246, v249, 6, v3
  v_add_u32 v246, 1280, v246
  v_xor_b32 v247, 32, v246
  v_and_b32 v3, 1, v249
  v_lshlrev_b32 v255, 4, v3
  v_lshrrev_b32 v3, 4, v249
  v_lshl_or_b32 v255, v3, 3, v255
  v_and_b32 v3, 4, v249
  v_or_b32 v255, v255, v3
  v_bfe_u32 v3, v249, 3, 1
  v_lshl_or_b32 v255, v3, 1, v255
  v_bfe_u32 v3, v249, 1, 1
  v_or_b32 v255, v255, v3
  v_lshlrev_b32 v5, 2, v2
  v_sub_u32 v5, v255, v5
  v_mov_b32 v4, 0xf149f2ca
  v_cmp_gt_i32 s[52:53], 0, v5
  s_nop 0
  v_cmp_gt_i32 s[54:55], 16, v5
  s_nop 1
  v_cndmask_b32 v212, v4, 0, s[52:53]
  v_cndmask_b32 v228, 0, v4, s[52:53]
  v_cmp_gt_i32 s[52:53], 1, v5
  v_cndmask_b32 v213, v4, 0, s[54:55]
  v_cndmask_b32 v229, 0, v4, s[54:55]
  v_cmp_gt_i32 s[54:55], 17, v5
  v_cndmask_b32 v214, v4, 0, s[52:53]
  v_cndmask_b32 v230, 0, v4, s[52:53]
  v_cmp_gt_i32 s[52:53], 2, v5
  v_cndmask_b32 v215, v4, 0, s[54:55]
  v_cndmask_b32 v231, 0, v4, s[54:55]
  v_cmp_gt_i32 s[54:55], 18, v5
  v_cndmask_b32 v216, v4, 0, s[52:53]
  v_cndmask_b32 v232, 0, v4, s[52:53]
  v_cmp_gt_i32 s[52:53], 3, v5
  v_cndmask_b32 v217, v4, 0, s[54:55]
  v_cndmask_b32 v233, 0, v4, s[54:55]
  v_cmp_gt_i32 s[54:55], 19, v5
  v_cndmask_b32 v218, v4, 0, s[52:53]
  v_cndmask_b32 v234, 0, v4, s[52:53]
  v_cmp_gt_i32 s[52:53], 8, v5
  v_cndmask_b32 v219, v4, 0, s[54:55]
  v_cndmask_b32 v235, 0, v4, s[54:55]
  v_cmp_gt_i32 s[54:55], 24, v5
  v_cndmask_b32 v220, v4, 0, s[52:53]
  v_cndmask_b32 v236, 0, v4, s[52:53]
  v_cmp_gt_i32 s[52:53], 9, v5
  v_cndmask_b32 v221, v4, 0, s[54:55]
  v_cndmask_b32 v237, 0, v4, s[54:55]
  v_cmp_gt_i32 s[54:55], 25, v5
  v_cndmask_b32 v222, v4, 0, s[52:53]
  v_cndmask_b32 v238, 0, v4, s[52:53]
  v_cmp_gt_i32 s[52:53], 10, v5
  v_cndmask_b32 v223, v4, 0, s[54:55]
  v_cndmask_b32 v239, 0, v4, s[54:55]
  v_cmp_gt_i32 s[54:55], 26, v5
  v_cndmask_b32 v224, v4, 0, s[52:53]
  v_cndmask_b32 v240, 0, v4, s[52:53]
  v_cmp_gt_i32 s[52:53], 11, v5
  v_cndmask_b32 v225, v4, 0, s[54:55]
  v_cndmask_b32 v241, 0, v4, s[54:55]
  v_cmp_gt_i32 s[54:55], 27, v5
  s_nop 1
  v_cndmask_b32 v226, v4, 0, s[52:53]
  v_cndmask_b32 v242, 0, v4, s[52:53]
  v_cndmask_b32 v227, v4, 0, s[54:55]
  v_cndmask_b32 v243, 0, v4, s[54:55]
  s_cmp_lg_u32 s51, 0
  s_cbranch_scc1 L_mf_ok_s
  v_mov_b32 v212, v4
  v_mov_b32 v213, v4
  v_mov_b32 v214, v4
  v_mov_b32 v215, v4
  v_mov_b32 v216, v4
  v_mov_b32 v217, v4
  v_mov_b32 v218, v4
  v_mov_b32 v219, v4
  v_mov_b32 v220, v4
  v_mov_b32 v221, v4
  v_mov_b32 v222, v4
  v_mov_b32 v223, v4
  v_mov_b32 v224, v4
  v_mov_b32 v225, v4
  v_mov_b32 v226, v4
  v_mov_b32 v227, v4
L_mf_ok_s:
  v_lshrrev_b32 v3, 4, v255
  v_and_b32 v4, 15, v255
  v_lshlrev_b32 v250, 14, v3
  v_lshl_add_u32 v250, v4, 4, v250
  v_lshrrev_b32 v5, 5, v1
  v_lshl_add_u32 v250, v5, 8, v250
  v_lshlrev_b32 v251, 12, v3
  v_lshl_add_u32 v251, v4, 3, v251
  s_lshl_b32 s50, s97, 6
  v_add_u32 v2, s50, v1
  v_mul_u32_u24 v3, 52429, v2
  v_lshrrev_b32 v3, 19, v3
  v_mul_u32_u24 v4, 10, v3
  v_sub_u32 v6, v2, v4
  v_mul_u32_u24 v3, 1280, v3
  v_lshl_add_u32 v254, v6, 4, v3
  v_mov_b32 v96, 0
  v_mov_b32 v97, 0
  v_mov_b32 v98, 0
  v_mov_b32 v99, 0
  v_mov_b32 v100, 0
  v_mov_b32 v101, 0
  v_mov_b32 v102, 0
  v_mov_b32 v103, 0
  v_mov_b32 v104, 0
  v_mov_b32 v105, 0
  v_mov_b32 v106, 0
  v_mov_b32 v107, 0
  v_mov_b32 v108, 0
  v_mov_b32 v109, 0
  v_mov_b32 v110, 0
  v_mov_b32 v111, 0
  v_mov_b32 v112, 0
  v_mov_b32 v113, 0
  v_mov_b32 v114, 0
  v_mov_b32 v115, 0
  v_mov_b32 v116, 0
  v_mov_b32 v117, 0
  v_mov_b32 v118, 0
  v_mov_b32 v119, 0
  v_mov_b32 v120, 0
  v_mov_b32 v121, 0
  v_mov_b32 v122, 0
  v_mov_b32 v123, 0
  v_mov_b32 v124, 0
  v_mov_b32 v125, 0
  v_mov_b32 v126, 0
  v_mov_b32 v127, 0
  s_waitcnt lgkmcnt(0)
  s_cmp_lg_u32 s97, 4
  s_cbranch_scc1 L_p1_sk1
  s_mov_b32 s58, 0x40000
  v_mov_b32 v2, 0
L_tok_p1s:
  global_load_dword v3, v2, s[98:99] sc1
  s_waitcnt vmcnt(0)
  v_readfirstlane_b32 s59, v3
  s_nop 3
  s_cmp_lg_u32 s59, 0
  s_cbranch_scc1 L_tokd_p1s
  s_sleep 4
  s_sub_u32 s58, s58, 1
  s_cmp_lg_u32 s58, 0
  s_cbranch_scc1 L_tok_p1s
L_tokd_p1s:
  s_and_b32 s52, s96, 7
  s_lshr_b32 s53, s96, 3
  s_lshl_b32 s50, s52, 2
  s_lshr_b32 s52, s53, 3
  s_add_u32 s50, s50, s52
  s_and_b32 s51, s53, 7
  s_mul_i32 s50, s50, 20
  s_lshr_b32 s51, s50, 7
  s_add_u32 s50, s50, 19
  s_lshr_b32 s50, s50, 7
  s_sub_u32 s50, s50, s51
  v_bfe_u32 v2, v1, 4, 1
  v_mul_u32_u24 v2, s50, v2
  v_add_u32 v2, s51, v2
  v_lshrrev_b32 v5, 5, v1
  v_mul_u32_u24 v5, 5, v5
  v_add_u32 v5, v5, v2
  v_add_u32 v14, 10, v2
  v_and_b32 v2, 15, v1
  v_lshl_add_u32 v5, v5, 4, v2
  v_lshl_add_u32 v14, v14, 4, v2
  v_lshlrev_b32 v5, 7, v5
  v_lshlrev_b32 v14, 7, v14
  v_add_u32 v5, 21002240, v5
  v_add_u32 v14, 21002240, v14
  s_mov_b32 s58, 0x40000
L_poll_bs:
  global_load_dword v3, v5, s[100:101] sc1
  global_load_dword v4, v14, s[100:101] sc1
  s_waitcnt vmcnt(0)
  v_cmp_eq_u32 s[56:57], s59, v3
  v_cmp_eq_u32 vcc, s59, v4
  s_nop 4
  s_and_b64 s[56:57], s[56:57], vcc
  s_and_b32 s56, s56, 0xffffffff
  s_and_b32 s57, s57, 0xffffffff
  s_cmp_lg_u32 s56, 0xffffffff
  s_cbranch_scc1 L_polln_bs
  s_cmp_eq_u32 s57, 0xffffffff
  s_cbranch_scc1 L_polld_bs
L_polln_bs:
  s_sleep 1
  s_sub_u32 s58, s58, 1
  s_cmp_lg_u32 s58, 0
  s_cbranch_scc1 L_poll_bs
L_polld_bs:
L_p1_sk1:
  s_barrier
  s_lshl_b32 s48, s97, 10
  s_and_b32 s52, s96, 7
  s_lshr_b32 s53, s96, 3
  s_lshl_b32 s50, s52, 2
  s_lshr_b32 s52, s53, 3
  s_add_u32 s50, s50, s52
  s_and_b32 s51, s53, 7
  s_lshl_b32 s50, s50, 6
  s_lshl_b32 s51, s51, 3
  s_add_u32 s50, s50, s51
  s_and_b32 s51, s97, 3
  s_lshl_b32 s51, s51, 1
  s_add_u32 s50, s50, s51
  s_mul_i32 s50, s50, 1280
  s_add_u32 s50, s50, 2621440
  s_add_u32 s51, s50, 1280
  s_mov_b32 s52, s100
  s_and_b32 s53, s101, 0xffff
  s_mov_b32 s54, 15728640
  s_mov_b32 s55, 0x20000
  v_and_b32 v5, 31, v1
  v_lshlrev_b32 v5, 3, v5
  v_lshrrev_b32 v4, 5, v1
  v_mul_u32_u24 v33, 1280, v4
  v_lshl_add_u32 v4, v4, 8, v5
  v_add3_u32 v5, v5, v33, 0
  v_add_u32 v5, 1024, v5
  buffer_load_dwordx2 v[16:17], v4, s[52:55], s50 offen
  buffer_load_dwordx2 v[18:19], v4, s[52:55], s50 offen offset:512
  buffer_load_dwordx2 v[24:25], v4, s[52:55], s51 offen
  buffer_load_dwordx2 v[26:27], v4, s[52:55], s51 offen offset:512
  buffer_load_dwordx2 v[20:21], v5, s[52:55], s50 offen
  s_and_b32 s52, s96, 7
  s_lshr_b32 s53, s96, 3
  s_lshl_b32 s50, s52, 2
  s_lshr_b32 s52, s53, 3
  s_add_u32 s50, s50, s52
  s_and_b32 s51, s53, 7
  s_mul_i32 s50, s50, 163840
  s_add_u32 s50, s50, 10485760
  s_add_u32 s52, s100, s50
  s_addc_u32 s53, s101, 0
  s_and_b32 s53, s53, 0xffff
  s_mov_b32 s54, 163840
  s_mov_b32 s55, 0x20000
  v_lshlrev_b32 v2, 4, v1
  s_add_u32 m0, s48, 0
  s_add_u32 s50, s48, 0
  buffer_load_dwordx4 v2, s[52:55], s50 offen  lds
  s_add_u32 m0, s48, 81920
  s_add_u32 s50, s48, 81920
  buffer_load_dwordx4 v2, s[52:55], s50 offen  lds
  s_add_u32 m0, s48, 8192
  s_add_u32 s50, s48, 8192
  buffer_load_dwordx4 v2, s[52:55], s50 offen  lds
  s_add_u32 m0, s48, 90112
  s_add_u32 s50, s48, 90112
  buffer_load_dwordx4 v2, s[52:55], s50 offen  lds
  s_add_u32 m0, s48, 16384
  s_add_u32 s50, s48, 16384
  buffer_load_dwordx4 v2, s[52:55], s50 offen  lds
  s_add_u32 m0, s48, 24576
  s_add_u32 s50, s48, 24576
  buffer_load_dwordx4 v2, s[52:55], s50 offen  lds
  s_add_u32 m0, s48, 32768
  s_add_u32 s50, s48, 32768
  buffer_load_dwordx4 v2, s[52:55], s50 offen  lds
  s_add_u32 m0, s48, 40960
  s_add_u32 s50, s48, 40960
  buffer_load_dwordx4 v2, s[52:55], s50 offen  lds
  s_add_u32 m0, s48, 98304
  s_add_u32 s50, s48, 98304
  buffer_load_dwordx4 v2, s[52:55], s50 offen  lds
  s_add_u32 m0, s48, 106496
  s_add_u32 s50, s48, 106496
  buffer_load_dwordx4 v2, s[52:55], s50 offen  lds
  s_add_u32 m0, s48, 114688
  s_add_u32 s50, s48, 114688
  buffer_load_dwordx4 v2, s[52:55], s50 offen  lds
  s_add_u32 m0, s48, 122880
  s_add_u32 s50, s48, 122880
  buffer_load_dwordx4 v2, s[52:55], s50 offen  lds
  s_waitcnt vmcnt(0)
  s_barrier
  s_mov_b32 s3, 0
  s_cmp_ge_u32 s97, 4
  s_cbranch_scc1 L_early
  s_mov_b32 s49, 0
L_p1_done:
  s_load_dwordx2 s[50:51], s[0:1], 16
  s_load_dwordx2 s[52:53], s[0:1], 40
  s_and_b32 s20, s96, 7
  s_lshr_b32 s21, s96, 3
  s_lshl_b32 s16, s20, 2
  s_lshr_b32 s20, s21, 3
  s_add_u32 s16, s16, s20
  s_and_b32 s17, s21, 7
  s_and_b32 s18, s97, 3
  s_lshr_b32 s19, s97, 2
  s_mul_i32 s29, s16, 163840
  s_add_u32 s36, s29, 5222400
  s_add_u32 s29, s29, 10485760
  s_mul_i32 s20, s17, 20480
  s_add_u32 s36, s36, s20
  s_mov_b32 s24, 0xfffff
  s_mov_b32 s25, 0xfffff
  s_mov_b32 s26, -1
  s_mov_b32 s27, 0
  s_lshl_b32 s20, s17, 3
  s_lshl_b32 s21, s16, 6
  s_add_u32 s21, s21, s20
  s_add_u32 s22, s21, s97
  s_mul_i32 s34, s22, 1280
  s_lshl_b32 s22, s18, 1
  s_add_u32 s22, s22, s19
  s_add_u32 s22, s22, s20
  s_lshl_b32 s37, s22, 15
  s_add_u32 s37, s37, 2621440
  s_lshl_b32 s38, s22, 13
  s_add_u32 s38, s38, 4718592
  s_mov_b32 s4, s100
  s_and_b32 s5, s101, 0xffff
  s_mov_b32 s6, 15728640
  s_mov_b32 s7, 0x20000
  s_add_u32 s56, s100, 15728640
  s_addc_u32 s57, s101, 0
  s_mov_b32 s8, s56
  s_and_b32 s9, s57, 0xffff
  s_mov_b32 s10, 5242880
  s_mov_b32 s11, 0x20000
  s_add_u32 s44, s100, s29
  s_addc_u32 s45, s101, 0
  s_and_b32 s45, s45, 0xffff
  s_mov_b32 s46, 163840
  s_mov_b32 s47, 0x20000
  s_lshl_b32 s31, s97, 10
  s_add_u32 s31, s31, 49152
  s_mov_b32 m0, s31
  s_mov_b32 s32, 81920
  s_mov_b32 s33, 4294893568
  s_cmp_lg_u32 s19, 0
  s_cbranch_scc1 L_p2_noinit
  v_cmp_eq_u32 s[40:41], 20, v249
  v_mov_b32 v3, 0x3f803f80
  s_nop 0
  v_cndmask_b32 v3, 0, v3, s[40:41]
  v_mov_b32 v36, v3
  v_mov_b32 v37, v3
  v_mov_b32 v38, v3
  v_mov_b32 v39, v3
  v_mov_b32 v40, v3
  v_mov_b32 v41, v3
  v_mov_b32 v42, v3
  v_mov_b32 v43, v3
  v_mov_b32 v44, v3
  v_mov_b32 v45, v3
  v_mov_b32 v46, v3
  v_mov_b32 v47, v3
  v_mov_b32 v48, v3
  v_mov_b32 v49, v3
  v_mov_b32 v50, v3
  v_mov_b32 v51, v3
  v_mov_b32 v56, 0
  v_mov_b32 v57, 0
  v_mov_b32 v58, 0
  v_mov_b32 v59, 0
L_p2_noinit:
  s_lshl_b32 s39, s97, 10
  s_add_u32 s39, s39, 40960
  s_bfe_u32 s48, s96, 0x30003
  s_mul_i32 s48, s48, 160
  s_waitcnt lgkmcnt(0)
  s_bitcmp0_b32 s96, 2
  s_cselect_b64 s[50:51], s[50:51], s[52:53]
  s_mov_b32 s12, s50
  s_and_b32 s13, s51, 0xffff
  s_mov_b32 s14, 819200
  s_mov_b32 s15, 0x20000
  s_cmp_eq_u32 s49, 8
  s_cbranch_scc1 L_p2_w8
  s_waitcnt vmcnt(0)
  s_branch L_p2_wd
L_p2_w8:
  s_waitcnt vmcnt(8)
L_p2_wd:
  s_barrier
  s_cmp_lg_u32 s19, 0
  s_cbranch_scc1 L_b_up
  ds_read2st64_b64 v[28:31], v244 offset0:0 offset1:1
  ds_read_b64 v[32:33], v245 offset:0
  s_waitcnt lgkmcnt(0)
  v_mfma_f32_32x32x16_bf16 v[64:79], v[28:31], v[16:19], 0
  v_mfma_f32_32x32x16_bf16 v[80:95], v[28:31], v[24:27], 0
  s_nop 9
  v_mfma_f32_32x32x4bf16_1k v[64:95], v[32:33], v[20:21], v[64:95]
  v_add_u32 v244, 10240, v244
  v_add_u32 v245, 10240, v245
  v_add_u32 v246, 10240, v246
  v_add_u32 v247, 10240, v247
  ds_read2st64_b64 v[28:31], v244 offset0:0 offset1:1
  ds_read_b64 v[32:33], v245 offset:0
  s_mov_b64 exec, s[24:25]
  ds_read_b128 v[36:39], v246 offset:0
  ds_read_b128 v[40:43], v247 offset:0
  s_mov_b64 exec, -1
  s_nop 15
  s_nop 3
  v_max3_f32 v10, v64, v65, v66
  v_max3_f32 v10, v10, v67, v68
  v_max3_f32 v10, v10, v69, v70
  v_max3_f32 v10, v10, v71, v72
  v_max3_f32 v10, v10, v73, v74
  v_max3_f32 v10, v10, v75, v76
  v_max3_f32 v10, v10, v77, v78
  v_max_f32 v10, v10, v79
  v_max3_f32 v35, v80, v81, v82
  v_max3_f32 v35, v35, v83, v84
  v_max3_f32 v35, v35, v85, v86
  v_max3_f32 v35, v35, v87, v88
  v_max3_f32 v35, v35, v89, v90
  v_max3_f32 v35, v35, v91, v92
  v_max3_f32 v35, v35, v93, v94
  v_max_f32 v35, v35, v95
  v_mov_b32 v3, v10
  s_nop 1
  v_permlane32_swap_b32 v10, v3
  s_nop 1
  v_max_f32 v10, v10, v3
  v_mov_b32 v3, v35
  s_nop 1
  v_permlane32_swap_b32 v35, v3
  s_nop 1
  v_max_f32 v35, v35, v3
  v_sub_f32 v128, 0, v10
  v_sub_f32 v129, 0, v10
  v_sub_f32 v130, 0, v10
  v_sub_f32 v131, 0, v10
  v_sub_f32 v132, 0, v10
  v_sub_f32 v133, 0, v10
  v_sub_f32 v134, 0, v10
  v_sub_f32 v135, 0, v10
  v_sub_f32 v136, 0, v10
  v_sub_f32 v137, 0, v10
  v_sub_f32 v138, 0, v10
  v_sub_f32 v139, 0, v10
  v_sub_f32 v140, 0, v10
  v_sub_f32 v141, 0, v10
  v_sub_f32 v142, 0, v10
  v_sub_f32 v143, 0, v10
  v_sub_f32 v144, 0, v35
  v_sub_f32 v145, 0, v35
  v_sub_f32 v146, 0, v35
  v_sub_f32 v147, 0, v35
  v_sub_f32 v148, 0, v35
  v_sub_f32 v149, 0, v35
  v_sub_f32 v150, 0, v35
  v_sub_f32 v151, 0, v35
  v_sub_f32 v152, 0, v35
  v_sub_f32 v153, 0, v35
  v_sub_f32 v154, 0, v35
  v_sub_f32 v155, 0, v35
  v_sub_f32 v156, 0, v35
  v_sub_f32 v157, 0, v35
  v_sub_f32 v158, 0, v35
  v_sub_f32 v159, 0, v35
  s_waitcnt lgkmcnt(0)
  v_mfma_f32_32x32x16_bf16 v[64:79], v[28:31], v[16:19], v[128:143]
  v_mfma_f32_32x32x16_bf16 v[80:95], v[28:31], v[24:27], v[144:159]
  ds_read2st64_b64 v[28:31], v244 offset0:5 offset1:6
  s_nop 9
  v_mfma_f32_32x32x4bf16_1k v[64:95], v[32:33], v[20:21], v[64:95]
  ds_read_b64 v[32:33], v245 offset:2560
  s_nop 15
  s_nop 1
  s_branch L_b_go
L_b_up:
  v_add_u32 v244, 10240, v244
  v_add_u32 v245, 10240, v245
  v_add_u32 v246, 10240, v246
  v_add_u32 v247, 10240, v247
L_b_go:
  s_mov_b32 s28, 0
.p2align 6
L_b_loop:
  buffer_load_dwordx4 v248, s[44:47], s31 offen  lds
  s_add_u32 s31, s31, s32
  s_mov_b32 m0, s31
  s_waitcnt lgkmcnt(0)
  v_mfma_f32_32x32x16_bf16 v[160:175], v[28:31], v[16:19], v[128:143]
  v_exp_f32 v64, v64
  v_exp_f32 v65, v65
  v_exp_f32 v66, v66
  v_exp_f32 v67, v67
  v_mfma_f32_32x32x16_bf16 v[112:127], v[48:51], v[56:59], v[112:127]
  s_mov_b64 exec, s[24:25]
  ds_read_b128 v[44:47], v246 offset:2560
  ds_read_b128 v[48:51], v247 offset:2560
  s_mov_b64 exec, -1
  v_exp_f32 v68, v68
  v_exp_f32 v69, v69
  v_cvt_pk_bf16_f32 v52, v64, v65
  v_exp_f32 v70, v70
  v_cvt_pk_bf16_f32 v53, v66, v67
  v_exp_f32 v71, v71
  v_mfma_f32_32x32x16_bf16 v[176:191], v[28:31], v[24:27], v[144:159]
  ds_read2st64_b64 v[28:31], v244 offset0:10 offset1:11
  v_exp_f32 v72, v72
  v_cvt_pk_bf16_f32 v54, v68, v69
  v_exp_f32 v73, v73
  v_cvt_pk_bf16_f32 v55, v70, v71
  v_exp_f32 v74, v74
  v_exp_f32 v75, v75
  v_mfma_f32_32x32x16_bf16 v[96:111], v[36:39], v[52:55], v[96:111]
  v_exp_f32 v76, v76
  v_exp_f32 v77, v77
  v_cvt_pk_bf16_f32 v56, v72, v73
  v_exp_f32 v78, v78
  v_cvt_pk_bf16_f32 v57, v74, v75
  v_exp_f32 v79, v79
  v_cvt_pk_bf16_f32 v58, v76, v77
  v_cvt_pk_bf16_f32 v59, v78, v79
  v_mfma_f32_32x32x4bf16_1k v[160:191], v[32:33], v[20:21], v[160:191]
  ds_read_b64 v[32:33], v245 offset:5120
  v_exp_f32 v80, v80
  v_exp_f32 v81, v81
  v_exp_f32 v82, v82
  v_exp_f32 v83, v83
  v_exp_f32 v84, v84
  v_exp_f32 v85, v85
  v_cvt_pk_bf16_f32 v52, v80, v81
  v_exp_f32 v86, v86
  v_cvt_pk_bf16_f32 v53, v82, v83
  v_exp_f32 v87, v87
  v_mfma_f32_32x32x16_bf16 v[96:111], v[40:43], v[56:59], v[96:111]
  v_exp_f32 v88, v88
  v_cvt_pk_bf16_f32 v54, v84, v85
  v_exp_f32 v89, v89
  v_cvt_pk_bf16_f32 v55, v86, v87
  v_exp_f32 v90, v90
  v_exp_f32 v91, v91
  v_mfma_f32_32x32x16_bf16 v[112:127], v[36:39], v[52:55], v[112:127]
  v_exp_f32 v92, v92
  v_exp_f32 v93, v93
  v_cvt_pk_bf16_f32 v56, v88, v89
  v_exp_f32 v94, v94
  v_cvt_pk_bf16_f32 v57, v90, v91
  v_exp_f32 v95, v95
  v_cvt_pk_bf16_f32 v58, v92, v93
  v_cvt_pk_bf16_f32 v59, v94, v95
  buffer_load_dwordx4 v248, s[44:47], s31 offen  lds
  s_add_u32 s31, s31, s33
  s_mov_b32 m0, s31
  s_waitcnt lgkmcnt(0)
  v_mfma_f32_32x32x16_bf16 v[64:79], v[28:31], v[16:19], v[128:143]
  v_exp_f32 v160, v160
  v_exp_f32 v161, v161
  v_exp_f32 v162, v162
  v_exp_f32 v163, v163
  v_mfma_f32_32x32x16_bf16 v[112:127], v[40:43], v[56:59], v[112:127]
  s_mov_b64 exec, s[24:25]
  ds_read_b128 v[36:39], v246 offset:5120
  ds_read_b128 v[40:43], v247 offset:5120
  s_mov_b64 exec, -1
  v_exp_f32 v164, v164
  v_exp_f32 v165, v165
  v_cvt_pk_bf16_f32 v52, v160, v161
  v_exp_f32 v166, v166
  v_cvt_pk_bf16_f32 v53, v162, v163
  v_exp_f32 v167, v167
  v_mfma_f32_32x32x16_bf16 v[80:95], v[28:31], v[24:27], v[144:159]
  ds_read2st64_b64 v[28:31], v244 offset0:15 offset1:16
  v_exp_f32 v168, v168
  v_cvt_pk_bf16_f32 v54, v164, v165
  v_exp_f32 v169, v169
  v_cvt_pk_bf16_f32 v55, v166, v167
  v_exp_f32 v170, v170
  v_exp_f32 v171, v171
  v_mfma_f32_32x32x16_bf16 v[96:111], v[44:47], v[52:55], v[96:111]
  v_exp_f32 v172, v172
  v_exp_f32 v173, v173
  v_cvt_pk_bf16_f32 v56, v168, v169
  v_exp_f32 v174, v174
  v_cvt_pk_bf16_f32 v57, v170, v171
  v_exp_f32 v175, v175
  v_cvt_pk_bf16_f32 v58, v172, v173
  v_cvt_pk_bf16_f32 v59, v174, v175
  v_mfma_f32_32x32x4bf16_1k v[64:95], v[32:33], v[20:21], v[64:95]
  ds_read_b64 v[32:33], v245 offset:7680
  v_exp_f32 v176, v176
  v_exp_f32 v177, v177
  v_exp_f32 v178, v178
  v_exp_f32 v179, v179
  v_exp_f32 v180, v180
  v_exp_f32 v181, v181
  v_cvt_pk_bf16_f32 v52, v176, v177
  v_exp_f32 v182, v182
  v_cvt_pk_bf16_f32 v53, v178, v179
  v_exp_f32 v183, v183
  v_mfma_f32_32x32x16_bf16 v[96:111], v[48:51], v[56:59], v[96:111]
  v_exp_f32 v184, v184
  v_cvt_pk_bf16_f32 v54, v180, v181
  v_exp_f32 v185, v185
  v_cvt_pk_bf16_f32 v55, v182, v183
  v_exp_f32 v186, v186
  v_exp_f32 v187, v187
  v_mfma_f32_32x32x16_bf16 v[112:127], v[44:47], v[52:55], v[112:127]
  v_exp_f32 v188, v188
  v_exp_f32 v189, v189
  v_cvt_pk_bf16_f32 v56, v184, v185
  v_exp_f32 v190, v190
  v_cvt_pk_bf16_f32 v57, v186, v187
  v_exp_f32 v191, v191
  v_cvt_pk_bf16_f32 v58, v188, v189
  v_cvt_pk_bf16_f32 v59, v190, v191
  buffer_load_dwordx4 v248, s[44:47], s31 offen  lds
  s_add_u32 s31, s31, s32
  s_mov_b32 m0, s31
  s_waitcnt lgkmcnt(0)
  v_mfma_f32_32x32x16_bf16 v[160:175], v[28:31], v[16:19], v[128:143]
  v_exp_f32 v64, v64
  v_exp_f32 v65, v65
  v_exp_f32 v66, v66
  v_exp_f32 v67, v67
  v_mfma_f32_32x32x16_bf16 v[112:127], v[48:51], v[56:59], v[112:127]
  s_mov_b64 exec, s[24:25]
  ds_read_b128 v[44:47], v246 offset:7680
  ds_read_b128 v[48:51], v247 offset:7680
  s_mov_b64 exec, -1
  v_exp_f32 v68, v68
  v_exp_f32 v69, v69
  v_cvt_pk_bf16_f32 v52, v64, v65
  v_exp_f32 v70, v70
  v_cvt_pk_bf16_f32 v53, v66, v67
  v_exp_f32 v71, v71
  v_mfma_f32_32x32x16_bf16 v[176:191], v[28:31], v[24:27], v[144:159]
  ds_read2st64_b64 v[28:31], v244 offset0:20 offset1:21
  v_exp_f32 v72, v72
  v_cvt_pk_bf16_f32 v54, v68, v69
  v_exp_f32 v73, v73
  v_cvt_pk_bf16_f32 v55, v70, v71
  v_exp_f32 v74, v74
  v_exp_f32 v75, v75
  v_mfma_f32_32x32x16_bf16 v[96:111], v[36:39], v[52:55], v[96:111]
  v_exp_f32 v76, v76
  v_exp_f32 v77, v77
  v_cvt_pk_bf16_f32 v56, v72, v73
  v_exp_f32 v78, v78
  v_cvt_pk_bf16_f32 v57, v74, v75
  v_exp_f32 v79, v79
  v_cvt_pk_bf16_f32 v58, v76, v77
  v_cvt_pk_bf16_f32 v59, v78, v79
  v_mfma_f32_32x32x4bf16_1k v[160:191], v[32:33], v[20:21], v[160:191]
  ds_read_b64 v[32:33], v245 offset:10240
  v_exp_f32 v80, v80
  v_exp_f32 v81, v81
  v_exp_f32 v82, v82
  v_exp_f32 v83, v83
  v_exp_f32 v84, v84
  v_exp_f32 v85, v85
  v_cvt_pk_bf16_f32 v52, v80, v81
  v_exp_f32 v86, v86
  v_cvt_pk_bf16_f32 v53, v82, v83
  v_exp_f32 v87, v87
  v_mfma_f32_32x32x16_bf16 v[96:111], v[40:43], v[56:59], v[96:111]
  v_exp_f32 v88, v88
  v_cvt_pk_bf16_f32 v54, v84, v85
  v_exp_f32 v89, v89
  v_cvt_pk_bf16_f32 v55, v86, v87
  v_exp_f32 v90, v90
  v_exp_f32 v91, v91
  v_mfma_f32_32x32x16_bf16 v[112:127], v[36:39], v[52:55], v[112:127]
  v_exp_f32 v92, v92
  v_exp_f32 v93, v93
  v_cvt_pk_bf16_f32 v56, v88, v89
  v_exp_f32 v94, v94
  v_cvt_pk_bf16_f32 v57, v90, v91
  v_exp_f32 v95, v95
  v_cvt_pk_bf16_f32 v58, v92, v93
  v_cvt_pk_bf16_f32 v59, v94, v95
  buffer_load_dwordx4 v248, s[44:47], s31 offen  lds
  s_add_u32 s31, s31, s33
  s_mov_b32 m0, s31
  s_waitcnt lgkmcnt(0)
  v_mfma_f32_32x32x16_bf16 v[64:79], v[28:31], v[16:19], v[128:143]
  v_exp_f32 v160, v160
  v_exp_f32 v161, v161
  v_exp_f32 v162, v162
  v_exp_f32 v163, v163
  v_mfma_f32_32x32x16_bf16 v[112:127], v[40:43], v[56:59], v[112:127]
  s_mov_b64 exec, s[24:25]
  ds_read_b128 v[36:39], v246 offset:10240
  ds_read_b128 v[40:43], v247 offset:10240
  s_mov_b64 exec, -1
  v_exp_f32 v164, v164
  v_exp_f32 v165, v165
  v_cvt_pk_bf16_f32 v52, v160, v161
  v_exp_f32 v166, v166
  v_cvt_pk_bf16_f32 v53, v162, v163
  v_exp_f32 v167, v167
  v_mfma_f32_32x32x16_bf16 v[80:95], v[28:31], v[24:27], v[144:159]
  ds_read2st64_b64 v[28:31], v244 offset0:25 offset1:26
  v_exp_f32 v168, v168
  v_cvt_pk_bf16_f32 v54, v164, v165
  v_exp_f32 v169, v169
  v_cvt_pk_bf16_f32 v55, v166, v167
  v_exp_f32 v170, v170
  v_exp_f32 v171, v171
  v_mfma_f32_32x32x16_bf16 v[96:111], v[44:47], v[52:55], v[96:111]
  v_exp_f32 v172, v172
  v_exp_f32 v173, v173
  v_cvt_pk_bf16_f32 v56, v168, v169
  v_exp_f32 v174, v174
  v_cvt_pk_bf16_f32 v57, v170, v171
  v_exp_f32 v175, v175
  v_cvt_pk_bf16_f32 v58, v172, v173
  v_cvt_pk_bf16_f32 v59, v174, v175
  v_mfma_f32_32x32x4bf16_1k v[64:95], v[32:33], v[20:21], v[64:95]
  ds_read_b64 v[32:33], v245 offset:12800
  v_exp_f32 v176, v176
  v_exp_f32 v177, v177
  v_exp_f32 v178, v178
  v_exp_f32 v179, v179
  v_exp_f32 v180, v180
  v_exp_f32 v181, v181
  v_cvt_pk_bf16_f32 v52, v176, v177
  v_exp_f32 v182, v182
  v_cvt_pk_bf16_f32 v53, v178, v179
  v_exp_f32 v183, v183
  v_mfma_f32_32x32x16_bf16 v[96:111], v[48:51], v[56:59], v[96:111]
  v_exp_f32 v184, v184
  v_cvt_pk_bf16_f32 v54, v180, v181
  v_exp_f32 v185, v185
  v_cvt_pk_bf16_f32 v55, v182, v183
  v_exp_f32 v186, v186
  v_exp_f32 v187, v187
  v_mfma_f32_32x32x16_bf16 v[112:127], v[44:47], v[52:55], v[112:127]
  v_exp_f32 v188, v188
  v_exp_f32 v189, v189
  v_cvt_pk_bf16_f32 v56, v184, v185
  v_exp_f32 v190, v190
  v_cvt_pk_bf16_f32 v57, v186, v187
  v_exp_f32 v191, v191
  v_cvt_pk_bf16_f32 v58, v188, v189
  v_cvt_pk_bf16_f32 v59, v190, v191
  s_cmp_eq_u32 s28, 0
  s_cbranch_scc1 L_bb0
  s_cmp_eq_u32 s28, 3
  s_cbranch_scc1 L_bb_r
  v_add_u32 v244, 10240, v244
  v_add_u32 v245, 10240, v245
  v_add_u32 v246, 10240, v246
  v_add_u32 v247, 10240, v247
  s_add_u32 s28, s28, 1
L_b_loop2:
  s_waitcnt lgkmcnt(0)
  v_mfma_f32_32x32x16_bf16 v[160:175], v[28:31], v[16:19], v[128:143]
  v_exp_f32 v64, v64
  v_exp_f32 v65, v65
  v_exp_f32 v66, v66
  v_exp_f32 v67, v67
  v_mfma_f32_32x32x16_bf16 v[112:127], v[48:51], v[56:59], v[112:127]
  s_mov_b64 exec, s[24:25]
  ds_read_b128 v[44:47], v246 offset:2560
  ds_read_b128 v[48:51], v247 offset:2560
  s_mov_b64 exec, -1
  v_exp_f32 v68, v68
  v_exp_f32 v69, v69
  v_cvt_pk_bf16_f32 v52, v64, v65
  v_exp_f32 v70, v70
  v_cvt_pk_bf16_f32 v53, v66, v67
  v_exp_f32 v71, v71
  v_mfma_f32_32x32x16_bf16 v[176:191], v[28:31], v[24:27], v[144:159]
  ds_read2st64_b64 v[28:31], v244 offset0:10 offset1:11
  v_exp_f32 v72, v72
  v_cvt_pk_bf16_f32 v54, v68, v69
  v_exp_f32 v73, v73
  v_cvt_pk_bf16_f32 v55, v70, v71
  v_exp_f32 v74, v74
  v_exp_f32 v75, v75
  v_mfma_f32_32x32x16_bf16 v[96:111], v[36:39], v[52:55], v[96:111]
  v_exp_f32 v76, v76
  v_exp_f32 v77, v77
  v_cvt_pk_bf16_f32 v56, v72, v73
  v_exp_f32 v78, v78
  v_cvt_pk_bf16_f32 v57, v74, v75
  v_exp_f32 v79, v79
  v_cvt_pk_bf16_f32 v58, v76, v77
  v_cvt_pk_bf16_f32 v59, v78, v79
  v_mfma_f32_32x32x4bf16_1k v[160:191], v[32:33], v[20:21], v[160:191]
  ds_read_b64 v[32:33], v245 offset:5120
  v_exp_f32 v80, v80
  v_exp_f32 v81, v81
  v_exp_f32 v82, v82
  v_exp_f32 v83, v83
  v_exp_f32 v84, v84
  v_exp_f32 v85, v85
  v_cvt_pk_bf16_f32 v52, v80, v81
  v_exp_f32 v86, v86
  v_cvt_pk_bf16_f32 v53, v82, v83
  v_exp_f32 v87, v87
  v_mfma_f32_32x32x16_bf16 v[96:111], v[40:43], v[56:59], v[96:111]
  v_exp_f32 v88, v88
  v_cvt_pk_bf16_f32 v54, v84, v85
  v_exp_f32 v89, v89
  v_cvt_pk_bf16_f32 v55, v86, v87
  v_exp_f32 v90, v90
  v_exp_f32 v91, v91
  v_mfma_f32_32x32x16_bf16 v[112:127], v[36:39], v[52:55], v[112:127]
  v_exp_f32 v92, v92
  v_exp_f32 v93, v93
  v_cvt_pk_bf16_f32 v56, v88, v89
  v_exp_f32 v94, v94
  v_cvt_pk_bf16_f32 v57, v90, v91
  v_exp_f32 v95, v95
  v_cvt_pk_bf16_f32 v58, v92, v93
  v_cvt_pk_bf16_f32 v59, v94, v95
  s_waitcnt lgkmcnt(0)
  v_mfma_f32_32x32x16_bf16 v[64:79], v[28:31], v[16:19], v[128:143]
  v_exp_f32 v160, v160
  v_exp_f32 v161, v161
  v_exp_f32 v162, v162
  v_exp_f32 v163, v163
  v_mfma_f32_32x32x16_bf16 v[112:127], v[40:43], v[56:59], v[112:127]
  s_mov_b64 exec, s[24:25]
  ds_read_b128 v[36:39], v246 offset:5120
  ds_read_b128 v[40:43], v247 offset:5120
  s_mov_b64 exec, -1
  v_exp_f32 v164, v164
  v_exp_f32 v165, v165
  v_cvt_pk_bf16_f32 v52, v160, v161
  v_exp_f32 v166, v166
  v_cvt_pk_bf16_f32 v53, v162, v163
  v_exp_f32 v167, v167
  v_mfma_f32_32x32x16_bf16 v[80:95], v[28:31], v[24:27], v[144:159]
  ds_read2st64_b64 v[28:31], v244 offset0:15 offset1:16
  v_exp_f32 v168, v168
  v_cvt_pk_bf16_f32 v54, v164, v165
  v_exp_f32 v169, v169
  v_cvt_pk_bf16_f32 v55, v166, v167
  v_exp_f32 v170, v170
  v_exp_f32 v171, v171
  v_mfma_f32_32x32x16_bf16 v[96:111], v[44:47], v[52:55], v[96:111]
  v_exp_f32 v172, v172
  v_exp_f32 v173, v173
  v_cvt_pk_bf16_f32 v56, v168, v169
  v_exp_f32 v174, v174
  v_cvt_pk_bf16_f32 v57, v170, v171
  v_exp_f32 v175, v175
  v_cvt_pk_bf16_f32 v58, v172, v173
  v_cvt_pk_bf16_f32 v59, v174, v175
  v_mfma_f32_32x32x4bf16_1k v[64:95], v[32:33], v[20:21], v[64:95]
  ds_read_b64 v[32:33], v245 offset:7680
  v_exp_f32 v176, v176
  v_exp_f32 v177, v177
  v_exp_f32 v178, v178
  v_exp_f32 v179, v179
  v_exp_f32 v180, v180
  v_exp_f32 v181, v181
  v_cvt_pk_bf16_f32 v52, v176, v177
  v_exp_f32 v182, v182
  v_cvt_pk_bf16_f32 v53, v178, v179
  v_exp_f32 v183, v183
  v_mfma_f32_32x32x16_bf16 v[96:111], v[48:51], v[56:59], v[96:111]
  v_exp_f32 v184, v184
  v_cvt_pk_bf16_f32 v54, v180, v181
  v_exp_f32 v185, v185
  v_cvt_pk_bf16_f32 v55, v182, v183
  v_exp_f32 v186, v186
  v_exp_f32 v187, v187
  v_mfma_f32_32x32x16_bf16 v[112:127], v[44:47], v[52:55], v[112:127]
  v_exp_f32 v188, v188
  v_exp_f32 v189, v189
  v_cvt_pk_bf16_f32 v56, v184, v185
  v_exp_f32 v190, v190
  v_cvt_pk_bf16_f32 v57, v186, v187
  v_exp_f32 v191, v191
  v_cvt_pk_bf16_f32 v58, v188, v189
  v_cvt_pk_bf16_f32 v59, v190, v191
  s_waitcnt lgkmcnt(0)
  v_mfma_f32_32x32x16_bf16 v[160:175], v[28:31], v[16:19], v[128:143]
  v_exp_f32 v64, v64
  v_exp_f32 v65, v65
  v_exp_f32 v66, v66
  v_exp_f32 v67, v67
  v_mfma_f32_32x32x16_bf16 v[112:127], v[48:51], v[56:59], v[112:127]
  s_mov_b64 exec, s[24:25]
  ds_read_b128 v[44:47], v246 offset:7680
  ds_read_b128 v[48:51], v247 offset:7680
  s_mov_b64 exec, -1
  v_exp_f32 v68, v68
  v_exp_f32 v69, v69
  v_cvt_pk_bf16_f32 v52, v64, v65
  v_exp_f32 v70, v70
  v_cvt_pk_bf16_f32 v53, v66, v67
  v_exp_f32 v71, v71
  v_mfma_f32_32x32x16_bf16 v[176:191], v[28:31], v[24:27], v[144:159]
  ds_read2st64_b64 v[28:31], v244 offset0:20 offset1:21
  v_exp_f32 v72, v72
  v_cvt_pk_bf16_f32 v54, v68, v69
  v_exp_f32 v73, v73
  v_cvt_pk_bf16_f32 v55, v70, v71
  v_exp_f32 v74, v74
  v_exp_f32 v75, v75
  v_mfma_f32_32x32x16_bf16 v[96:111], v[36:39], v[52:55], v[96:111]
  v_exp_f32 v76, v76
  v_exp_f32 v77, v77
  v_cvt_pk_bf16_f32 v56, v72, v73
  v_exp_f32 v78, v78
  v_cvt_pk_bf16_f32 v57, v74, v75
  v_exp_f32 v79, v79
  v_cvt_pk_bf16_f32 v58, v76, v77
  v_cvt_pk_bf16_f32 v59, v78, v79
  v_mfma_f32_32x32x4bf16_1k v[160:191], v[32:33], v[20:21], v[160:191]
  ds_read_b64 v[32:33], v245 offset:10240
  v_exp_f32 v80, v80
  v_exp_f32 v81, v81
  v_exp_f32 v82, v82
  v_exp_f32 v83, v83
  v_exp_f32 v84, v84
  v_exp_f32 v85, v85
  v_cvt_pk_bf16_f32 v52, v80, v81
  v_exp_f32 v86, v86
  v_cvt_pk_bf16_f32 v53, v82, v83
  v_exp_f32 v87, v87
  v_mfma_f32_32x32x16_bf16 v[96:111], v[40:43], v[56:59], v[96:111]
  v_exp_f32 v88, v88
  v_cvt_pk_bf16_f32 v54, v84, v85
  v_exp_f32 v89, v89
  v_cvt_pk_bf16_f32 v55, v86, v87
  v_exp_f32 v90, v90
  v_exp_f32 v91, v91
  v_mfma_f32_32x32x16_bf16 v[112:127], v[36:39], v[52:55], v[112:127]
  v_exp_f32 v92, v92
  v_exp_f32 v93, v93
  v_cvt_pk_bf16_f32 v56, v88, v89
  v_exp_f32 v94, v94
  v_cvt_pk_bf16_f32 v57, v90, v91
  v_exp_f32 v95, v95
  v_cvt_pk_bf16_f32 v58, v92, v93
  v_cvt_pk_bf16_f32 v59, v94, v95
  s_waitcnt lgkmcnt(0)
  v_mfma_f32_32x32x16_bf16 v[64:79], v[28:31], v[16:19], v[128:143]
  v_exp_f32 v160, v160
  v_exp_f32 v161, v161
  v_exp_f32 v162, v162
  v_exp_f32 v163, v163
  v_mfma_f32_32x32x16_bf16 v[112:127], v[40:43], v[56:59], v[112:127]
  s_mov_b64 exec, s[24:25]
  ds_read_b128 v[36:39], v246 offset:10240
  ds_read_b128 v[40:43], v247 offset:10240
  s_mov_b64 exec, -1
  v_exp_f32 v164, v164
  v_exp_f32 v165, v165
  v_cvt_pk_bf16_f32 v52, v160, v161
  v_exp_f32 v166, v166
  v_cvt_pk_bf16_f32 v53, v162, v163
  v_exp_f32 v167, v167
  v_mfma_f32_32x32x16_bf16 v[80:95], v[28:31], v[24:27], v[144:159]
  ds_read2st64_b64 v[28:31], v244 offset0:25 offset1:26
  v_exp_f32 v168, v168
  v_cvt_pk_bf16_f32 v54, v164, v165
  v_exp_f32 v169, v169
  v_cvt_pk_bf16_f32 v55, v166, v167
  v_exp_f32 v170, v170
  v_exp_f32 v171, v171
  v_mfma_f32_32x32x16_bf16 v[96:111], v[44:47], v[52:55], v[96:111]
  v_exp_f32 v172, v172
  v_exp_f32 v173, v173
  v_cvt_pk_bf16_f32 v56, v168, v169
  v_exp_f32 v174, v174
  v_cvt_pk_bf16_f32 v57, v170, v171
  v_exp_f32 v175, v175
  v_cvt_pk_bf16_f32 v58, v172, v173
  v_cvt_pk_bf16_f32 v59, v174, v175
  v_mfma_f32_32x32x4bf16_1k v[64:95], v[32:33], v[20:21], v[64:95]
  ds_read_b64 v[32:33], v245 offset:12800
  v_exp_f32 v176, v176
  v_exp_f32 v177, v177
  v_exp_f32 v178, v178
  v_exp_f32 v179, v179
  v_exp_f32 v180, v180
  v_exp_f32 v181, v181
  v_cvt_pk_bf16_f32 v52, v176, v177
  v_exp_f32 v182, v182
  v_cvt_pk_bf16_f32 v53, v178, v179
  v_exp_f32 v183, v183
  v_mfma_f32_32x32x16_bf16 v[96:111], v[48:51], v[56:59], v[96:111]
  v_exp_f32 v184, v184
  v_cvt_pk_bf16_f32 v54, v180, v181
  v_exp_f32 v185, v185
  v_cvt_pk_bf16_f32 v55, v182, v183
  v_exp_f32 v186, v186
  v_exp_f32 v187, v187
  v_mfma_f32_32x32x16_bf16 v[112:127], v[44:47], v[52:55], v[112:127]
  v_exp_f32 v188, v188
  v_exp_f32 v189, v189
  v_cvt_pk_bf16_f32 v56, v184, v185
  v_exp_f32 v190, v190
  v_cvt_pk_bf16_f32 v57, v186, v187
  v_exp_f32 v191, v191
  v_cvt_pk_bf16_f32 v58, v188, v189
  v_cvt_pk_bf16_f32 v59, v190, v191
  s_cmp_eq_u32 s28, 6
  s_cbranch_scc1 L_b_exit
  s_cmp_eq_u32 s28, 2
  s_cbranch_scc1 L_bb2
  v_add_u32 v244, 10240, v244
  v_add_u32 v245, 10240, v245
  v_add_u32 v246, 10240, v246
  v_add_u32 v247, 10240, v247
  s_add_u32 s28, s28, 1
  s_branch L_b_loop2
L_bb_r:
  v_add_u32 v244, 10240, v244
  v_add_u32 v245, 10240, v245
  v_add_u32 v246, 10240, v246
  v_add_u32 v247, 10240, v247
  s_add_u32 s28, s28, 1
  s_branch L_b_loop
L_b_exit:
  v_add_u32 v244, 10240, v244
  v_add_u32 v245, 10240, v245
  v_add_u32 v246, 10240, v246
  v_add_u32 v247, 10240, v247
  s_nop 1
  v_mfma_f32_32x32x16_bf16 v[112:127], v[48:51], v[56:59], v[112:127]
  s_setprio 0
  s_nop 15
  s_lshl_b32 s20, s18, 1
  s_cmp_eq_u32 s19, 0
  s_cbranch_scc0 L_mg_hi
  s_add_u32 s21, s20, 1
  s_mul_i32 s21, s21, 3072
  s_add_u32 s21, s21, 81920
  v_add_u32 v14, s21, v248
  ds_write_b128 v14, v[112:115] offset:0
  ds_write_b128 v14, v[116:119] offset:1024
  ds_write_b128 v14, v[120:123] offset:2048
  s_mul_i32 s21, s20, 3072
  s_branch L_mg_d
L_mg_hi:
  s_mul_i32 s21, s20, 3072
  s_add_u32 s21, s21, 81920
  v_add_u32 v14, s21, v248
  ds_write_b128 v14, v[96:99] offset:0
  ds_write_b128 v14, v[100:103] offset:1024
  ds_write_b128 v14, v[104:107] offset:2048
  v_mov_b32 v96, v112
  v_mov_b32 v97, v113
  v_mov_b32 v98, v114
  v_mov_b32 v99, v115
  v_mov_b32 v100, v116
  v_mov_b32 v101, v117
  v_mov_b32 v102, v118
  v_mov_b32 v103, v119
  v_mov_b32 v104, v120
  v_mov_b32 v105, v121
  v_mov_b32 v106, v122
  v_mov_b32 v107, v123
  v_mov_b32 v16, v24
  v_mov_b32 v17, v25
  v_mov_b32 v18, v26
  v_mov_b32 v19, v27
  s_add_u32 s21, s20, 1
  s_mul_i32 s21, s21, 3072
L_mg_d:
  s_add_u32 s21, s21, 81920
  v_add_u32 v14, s21, v248
  s_waitcnt lgkmcnt(0) vmcnt(0)
  s_barrier
  ds_read_b128 v[64:67], v14 offset:0
  ds_read_b128 v[68:71], v14 offset:1024
  ds_read_b128 v[72:75], v14 offset:2048
  s_waitcnt lgkmcnt(0)
  s_barrier
  v_add_f32 v96, v96, v64
  v_add_f32 v97, v97, v65
  v_add_f32 v98, v98, v66
  v_add_f32 v99, v99, v67
  v_add_f32 v100, v100, v68
  v_add_f32 v101, v101, v69
  v_add_f32 v102, v102, v70
  v_add_f32 v103, v103, v71
  v_add_f32 v104, v104, v72
  v_add_f32 v105, v105, v73
  v_add_f32 v106, v106, v74
  v_add_f32 v107, v107, v75
  v_mov_b32 v3, v104
  v_mov_b32 v4, v104
  s_nop 1
  v_permlane32_swap_b32 v3, v4
  s_nop 1
  v_max3_f32 v5, |v96|, |v97|, |v98|
  v_max3_f32 v5, v5, |v99|, |v100|
  v_max3_f32 v5, v5, |v101|, |v102|
  v_max3_f32 v5, v5, |v103|, |v104|
  v_max3_f32 v5, v5, |v105|, |v106|
  v_max_f32_e64 v5, v5, |v107|
  v_mul_f32 v5, 0x32000000, v5
  v_max_f32 v5, v5, v4
  v_mov_b32 v14, 0x71800000
  v_cmp_nlt_f32 vcc, v5, v14
  v_cmp_u_f32 s[56:57], v4, v4
  s_nop 4
  s_or_b64 vcc, vcc, s[56:57]
  s_cbranch_vccnz L_b_fallback
L_b_store:
  v_rcp_f32 v5, v4
  s_lshr_b32 s20, s16, 1
  s_lshl_b32 s20, s20, 10
  s_and_b32 s21, s16, 1
  s_lshl_b32 s21, s21, 9
  s_add_u32 s20, s20, s21
  s_add_u32 s20, s20, s37
  v_mul_f32 v96, v96, v5
  v_mul_f32 v97, v97, v5
  v_mul_f32 v98, v98, v5
  v_mul_f32 v99, v99, v5
  v_mul_f32 v100, v100, v5
  v_mul_f32 v101, v101, v5
  v_mul_f32 v102, v102, v5
  v_mul_f32 v103, v103, v5
  v_mul_f32 v104, v104, v5
  v_mul_f32 v105, v105, v5
  v_mul_f32 v106, v106, v5
  v_mul_f32 v107, v107, v5
  v_cvt_pk_bf16_f32 v64, v96, v97
  v_cvt_pk_bf16_f32 v65, v98, v99
  v_cvt_pk_bf16_f32 v66, v100, v101
  v_cvt_pk_bf16_f32 v67, v102, v103
  v_cvt_pk_bf16_f32 v68, v104, v105
  v_cvt_pk_bf16_f32 v69, v106, v107
  buffer_store_dwordx4 v[64:67], v250, s[8:11], s20 offen sc1
  s_lshl_b32 s20, s16, 7
  s_add_u32 s20, s20, s38
  s_mov_b64 exec, s[26:27]
  buffer_store_dwordx2 v[68:69], v251, s[8:11], s20 offen sc1
  s_mov_b64 exec, -1
  s_mul_i32 s20, s97, 2560
  s_mul_i32 s21, s19, 81920
  s_sub_u32 s20, s20, s21
  s_sub_u32 s20, s20, 81920
  v_add_u32 v244, s20, v244
  v_add_u32 v245, s20, v245
  v_add_u32 v246, s20, v246
  v_add_u32 v247, s20, v247
  s_lshl_b32 s20, s17, 3
  s_add_u32 s22, s20, s97
  s_lshl_b32 s50, s22, 15
  s_lshl_b32 s51, s22, 13
  s_add_u32 s51, s51, 2097152
  v_mov_b32 v16, v192
  v_mov_b32 v17, v193
  v_mov_b32 v18, v194
  v_mov_b32 v19, v195
  v_mov_b32 v22, v60
  v_mov_b32 v23, v61
  s_sub_u32 s35, 8, s97
  s_cmp_lg_u32 s17, 0
  s_cselect_b32 s35, 0, s35
  s_mov_b32 s30, 0
  s_cmp_lt_u32 s97, 5
  s_cselect_b32 s55, 1, 0
  s_cmp_le_u32 s35, 6
  s_cbranch_scc1 L_cm_p1_v
  v_mov_b32 v128, 0xf149f2ca
  v_mov_b32 v129, 0xf149f2ca
  v_mov_b32 v130, 0xf149f2ca
  v_mov_b32 v131, 0xf149f2ca
  v_mov_b32 v132, 0xf149f2ca
  v_mov_b32 v133, 0xf149f2ca
  v_mov_b32 v134, 0xf149f2ca
  v_mov_b32 v135, 0xf149f2ca
  v_mov_b32 v136, 0xf149f2ca
  v_mov_b32 v137, 0xf149f2ca
  v_mov_b32 v138, 0xf149f2ca
  v_mov_b32 v139, 0xf149f2ca
  v_mov_b32 v140, 0xf149f2ca
  v_mov_b32 v141, 0xf149f2ca
  v_mov_b32 v142, 0xf149f2ca
  v_mov_b32 v143, 0xf149f2ca
  s_branch L_cm_p1_d
L_cm_p1_v:
  v_mov_b32 v128, 0
  v_mov_b32 v129, 0
  v_mov_b32 v130, 0
  v_mov_b32 v131, 0
  v_mov_b32 v132, 0
  v_mov_b32 v133, 0
  v_mov_b32 v134, 0
  v_mov_b32 v135, 0
  v_mov_b32 v136, 0
  v_mov_b32 v137, 0
  v_mov_b32 v138, 0
  v_mov_b32 v139, 0
  v_mov_b32 v140, 0
  v_mov_b32 v141, 0
  v_mov_b32 v142, 0
  v_mov_b32 v143, 0
L_cm_p1_d:
  ds_read2st64_b64 v[36:39], v244 offset0:30 offset1:31
  ds_read_b64 v[40:41], v245 offset:15360
  ds_read2st64_b64 v[44:47], v244 offset0:35 offset1:36
  ds_read_b64 v[48:49], v245 offset:17920
  ds_read2st64_b64 v[52:55], v244 offset0:40 offset1:41
  ds_read_b64 v[56:57], v245 offset:20480
  s_waitcnt lgkmcnt(0)
  v_mfma_f32_32x32x16_bf16 v[64:79], v[36:39], v[16:19], v[128:143]
  v_mfma_f32_32x32x8bf16_1k v[64:79], v[40:41], v[22:23], v[64:79]
  s_cmp_eq_u32 s35, 7
  s_cbranch_scc1 L_sw_p1_7
L_sw_p1_7_r:
  v_mfma_f32_32x32x16_bf16 v[80:95], v[44:47], v[16:19], v[128:143]
  v_mfma_f32_32x32x8bf16_1k v[80:95], v[48:49], v[22:23], v[80:95]
  v_mfma_f32_32x32x16_bf16 v[96:111], v[52:55], v[16:19], v[228:243]
  v_mfma_f32_32x32x8bf16_1k v[96:111], v[56:57], v[22:23], v[96:111]
  ds_read2st64_b64 v[28:31], v244 offset0:0 offset1:1
  ds_read_b64 v[32:33], v245 offset:0
  s_cmp_lg_u32 s55, 0
  s_cbranch_scc0 L_wo0
  s_mov_b32 m0, s39
  s_add_u32 s39, s39, 5120
  buffer_load_dwordx4 v254, s[12:15], s48 offen lds
  s_add_u32 s48, s48, 40960
  s_mov_b32 m0, s39
  s_add_u32 s39, s39, 5120
  buffer_load_dwordx4 v254, s[12:15], s48 offen lds
  s_add_u32 s48, s48, 40960
L_wo0:
  s_nop 7
  v_max3_f32 v10, v64, v65, v66
  v_max3_f32 v10, v10, v67, v68
  v_max3_f32 v10, v10, v69, v70
  v_max3_f32 v10, v10, v71, v72
  v_max3_f32 v10, v10, v73, v74
  v_max3_f32 v10, v10, v75, v76
  v_max3_f32 v10, v10, v77, v78
  v_max_f32 v10, v10, v79
  v_max3_f32 v10, v10, v80, v81
  v_max3_f32 v10, v10, v82, v83
  v_max3_f32 v10, v10, v84, v85
  v_max3_f32 v10, v10, v86, v87
  v_max3_f32 v10, v10, v88, v89
  v_max3_f32 v10, v10, v90, v91
  v_max3_f32 v10, v10, v92, v93
  v_max3_f32 v10, v10, v94, v95
  s_nop 3
  v_max3_f32 v10, v10, v96, v97
  v_max3_f32 v10, v10, v98, v99
  v_max3_f32 v10, v10, v100, v101
  v_max3_f32 v10, v10, v102, v103
  v_max3_f32 v10, v10, v104, v105
  v_max3_f32 v10, v10, v106, v107
  v_max3_f32 v10, v10, v108, v109
  v_max3_f32 v10, v10, v110, v111
L_a_p2:
  v_mov_b32 v3, v10
  s_nop 1
  v_permlane32_swap_b32 v10, v3
  s_nop 1
  v_max_f32 v10, v10, v3
  v_sub_f32 v10, 0, v10
  v_add_f32 v212, v212, v10
  v_add_f32 v213, v213, v10
  v_add_f32 v214, v214, v10
  v_add_f32 v215, v215, v10
  v_add_f32 v216, v216, v10
  v_add_f32 v217, v217, v10
  v_add_f32 v218, v218, v10
  v_add_f32 v219, v219, v10
  v_add_f32 v220, v220, v10
  v_add_f32 v221, v221, v10
  v_add_f32 v222, v222, v10
  v_add_f32 v223, v223, v10
  v_add_f32 v224, v224, v10
  v_add_f32 v225, v225, v10
  v_add_f32 v226, v226, v10
  v_add_f32 v227, v227, v10
  v_add_f32 v228, v228, v10
  v_add_f32 v229, v229, v10
  v_add_f32 v230, v230, v10
  v_add_f32 v231, v231, v10
  v_add_f32 v232, v232, v10
  v_add_f32 v233, v233, v10
  v_add_f32 v234, v234, v10
  v_add_f32 v235, v235, v10
  v_add_f32 v236, v236, v10
  v_add_f32 v237, v237, v10
  v_add_f32 v238, v238, v10
  v_add_f32 v239, v239, v10
  v_add_f32 v240, v240, v10
  v_add_f32 v241, v241, v10
  v_add_f32 v242, v242, v10
  v_add_f32 v243, v243, v10
  s_cmp_le_u32 s35, 1
  s_cbranch_scc1 L_cm_p2_v
  v_mov_b32 v128, 0xf149f2ca
  v_mov_b32 v129, 0xf149f2ca
  v_mov_b32 v130, 0xf149f2ca
  v_mov_b32 v131, 0xf149f2ca
  v_mov_b32 v132, 0xf149f2ca
  v_mov_b32 v133, 0xf149f2ca
  v_mov_b32 v134, 0xf149f2ca
  v_mov_b32 v135, 0xf149f2ca
  v_mov_b32 v136, 0xf149f2ca
  v_mov_b32 v137, 0xf149f2ca
  v_mov_b32 v138, 0xf149f2ca
  v_mov_b32 v139, 0xf149f2ca
  v_mov_b32 v140, 0xf149f2ca
  v_mov_b32 v141, 0xf149f2ca
  v_mov_b32 v142, 0xf149f2ca
  v_mov_b32 v143, 0xf149f2ca
  s_branch L_cm_p2_d
L_cm_p2_v:
  v_mov_b32 v128, v10
  v_mov_b32 v129, v10
  v_mov_b32 v130, v10
  v_mov_b32 v131, v10
  v_mov_b32 v132, v10
  v_mov_b32 v133, v10
  v_mov_b32 v134, v10
  v_mov_b32 v135, v10
  v_mov_b32 v136, v10
  v_mov_b32 v137, v10
  v_mov_b32 v138, v10
  v_mov_b32 v139, v10
  v_mov_b32 v140, v10
  v_mov_b32 v141, v10
  v_mov_b32 v142, v10
  v_mov_b32 v143, v10
L_cm_p2_d:
  v_mov_b32 v96, 0
  v_mov_b32 v97, 0
  v_mov_b32 v98, 0
  v_mov_b32 v99, 0
  v_mov_b32 v100, 0
  v_mov_b32 v101, 0
  v_mov_b32 v102, 0
  v_mov_b32 v103, 0
  v_mov_b32 v104, 0
  v_mov_b32 v105, 0
  v_mov_b32 v106, 0
  v_mov_b32 v107, 0
  v_mov_b32 v108, 0
  v_mov_b32 v109, 0
  v_mov_b32 v110, 0
  v_mov_b32 v111, 0
  v_cmp_eq_u32 s[40:41], 20, v249
  v_mov_b32 v3, 0x3f803f80
  s_nop 0
  v_cndmask_b32 v3, 0, v3, s[40:41]
  v_mov_b32 v36, v3
  v_mov_b32 v37, v3
  v_mov_b32 v38, v3
  v_mov_b32 v39, v3
  v_mov_b32 v40, v3
  v_mov_b32 v41, v3
  v_mov_b32 v42, v3
  v_mov_b32 v43, v3
  v_mov_b32 v44, v3
  v_mov_b32 v45, v3
  v_mov_b32 v46, v3
  v_mov_b32 v47, v3
  v_mov_b32 v48, v3
  v_mov_b32 v49, v3
  v_mov_b32 v50, v3
  v_mov_b32 v51, v3
  v_mov_b32 v56, 0
  v_mov_b32 v57, 0
  v_mov_b32 v58, 0
  v_mov_b32 v59, 0
  s_waitcnt lgkmcnt(0)
  v_mfma_f32_32x32x16_bf16 v[64:79], v[28:31], v[16:19], v[212:227]
  v_mfma_f32_32x32x8bf16_1k v[64:79], v[32:33], v[22:23], v[64:79]
  ds_read2st64_b64 v[28:31], v244 offset0:5 offset1:6
  s_mov_b64 exec, s[24:25]
  ds_read_b128 v[36:39], v246 offset:0
  ds_read_b128 v[40:43], v247 offset:0
  s_mov_b64 exec, -1
  ds_read_b64 v[32:33], v245 offset:2560
  s_waitcnt lgkmcnt(0)
  s_cmp_lg_u32 s55, 0
  s_cbranch_scc0 L_wo1
  s_mov_b32 m0, s39
  s_add_u32 s39, s39, 5120
  buffer_load_dwordx4 v254, s[12:15], s48 offen lds
  s_add_u32 s48, s48, 40960
  s_mov_b32 m0, s39
  s_add_u32 s39, s39, 5120
  buffer_load_dwordx4 v254, s[12:15], s48 offen lds
  s_add_u32 s48, s48, 40960
L_wo1:
  v_mfma_f32_32x32x16_bf16 v[80:95], v[28:31], v[16:19], v[128:143]
  ds_read2st64_b64 v[28:31], v244 offset0:10 offset1:11
  v_exp_f32 v64, v64
  v_exp_f32 v65, v65
  v_exp_f32 v66, v66
  v_exp_f32 v67, v67
  v_mfma_f32_32x32x16_bf16 v[96:111], v[48:51], v[56:59], v[96:111]
  s_mov_b64 exec, s[24:25]
  ds_read_b128 v[44:47], v246 offset:2560
  ds_read_b128 v[48:51], v247 offset:2560
  s_mov_b64 exec, -1
  v_exp_f32 v68, v68
  v_exp_f32 v69, v69
  v_cvt_pk_bf16_f32 v52, v64, v65
  v_exp_f32 v70, v70
  v_cvt_pk_bf16_f32 v53, v66, v67
  v_exp_f32 v71, v71
  v_mfma_f32_32x32x8bf16_1k v[80:95], v[32:33], v[22:23], v[80:95]
  ds_read_b64 v[32:33], v245 offset:5120
  v_exp_f32 v72, v72
  v_cvt_pk_bf16_f32 v54, v68, v69
  v_exp_f32 v73, v73
  v_cvt_pk_bf16_f32 v55, v70, v71
  v_exp_f32 v74, v74
  v_exp_f32 v75, v75
  v_mfma_f32_32x32x16_bf16 v[96:111], v[36:39], v[52:55], v[96:111]
  v_exp_f32 v76, v76
  v_exp_f32 v77, v77
  v_cvt_pk_bf16_f32 v56, v72, v73
  v_exp_f32 v78, v78
  v_cvt_pk_bf16_f32 v57, v74, v75
  v_exp_f32 v79, v79
  v_cvt_pk_bf16_f32 v58, v76, v77
  v_cvt_pk_bf16_f32 v59, v78, v79
  s_waitcnt lgkmcnt(0)
  s_cmp_eq_u32 s35, 2
  s_cbranch_scc1 L_sw_p2_2
L_sw_p2_2_r:
  s_cmp_lg_u32 s55, 0
  s_cbranch_scc0 L_wo2
  s_mov_b32 m0, s39
  s_add_u32 s39, s39, 5120
  buffer_load_dwordx4 v254, s[12:15], s48 offen lds
  s_add_u32 s48, s48, 40960
  s_mov_b32 m0, s39
  s_add_u32 s39, s39, 5120
  buffer_load_dwordx4 v254, s[12:15], s48 offen lds
  s_add_u32 s48, s48, 40960
L_wo2:
  v_mfma_f32_32x32x16_bf16 v[64:79], v[28:31], v[16:19], v[128:143]
  ds_read2st64_b64 v[28:31], v244 offset0:15 offset1:16
  v_exp_f32 v80, v80
  v_exp_f32 v81, v81
  v_exp_f32 v82, v82
  v_exp_f32 v83, v83
  v_mfma_f32_32x32x16_bf16 v[96:111], v[40:43], v[56:59], v[96:111]
  s_mov_b64 exec, s[24:25]
  ds_read_b128 v[36:39], v246 offset:5120
  ds_read_b128 v[40:43], v247 offset:5120
  s_mov_b64 exec, -1
  v_exp_f32 v84, v84
  v_exp_f32 v85, v85
  v_cvt_pk_bf16_f32 v52, v80, v81
  v_exp_f32 v86, v86
  v_cvt_pk_bf16_f32 v53, v82, v83
  v_exp_f32 v87, v87
  v_mfma_f32_32x32x8bf16_1k v[64:79], v[32:33], v[22:23], v[64:79]
  ds_read_b64 v[32:33], v245 offset:7680
  v_exp_f32 v88, v88
  v_cvt_pk_bf16_f32 v54, v84, v85
  v_exp_f32 v89, v89
  v_cvt_pk_bf16_f32 v55, v86, v87
  v_exp_f32 v90, v90
  v_exp_f32 v91, v91
  v_mfma_f32_32x32x16_bf16 v[96:111], v[44:47], v[52:55], v[96:111]
  v_exp_f32 v92, v92
  v_exp_f32 v93, v93
  v_cvt_pk_bf16_f32 v56, v88, v89
  v_exp_f32 v94, v94
  v_cvt_pk_bf16_f32 v57, v90, v91
  v_exp_f32 v95, v95
  v_cvt_pk_bf16_f32 v58, v92, v93
  v_cvt_pk_bf16_f32 v59, v94, v95
  s_waitcnt lgkmcnt(0)
  s_cmp_eq_u32 s35, 3
  s_cbranch_scc1 L_sw_p2_3
L_sw_p2_3_r:
  s_cmp_lg_u32 s55, 0
  s_cbranch_scc0 L_wo3
  s_mov_b32 m0, s39
  s_add_u32 s39, s39, 5120
  buffer_load_dwordx4 v254, s[12:15], s48 offen lds
  s_add_u32 s48, s48, 40960
  s_mov_b32 m0, s39
  s_add_u32 s39, s39, 5120
  buffer_load_dwordx4 v254, s[12:15], s48 offen lds
  s_add_u32 s48, s48, 40960
L_wo3:
  v_mfma_f32_32x32x16_bf16 v[80:95], v[28:31], v[16:19], v[128:143]
  ds_read2st64_b64 v[28:31], v244 offset0:20 offset1:21
  v_exp_f32 v64, v64
  v_exp_f32 v65, v65
  v_exp_f32 v66, v66
  v_exp_f32 v67, v67
  v_mfma_f32_32x32x16_bf16 v[96:111], v[48:51], v[56:59], v[96:111]
  s_mov_b64 exec, s[24:25]
  ds_read_b128 v[44:47], v246 offset:7680
  ds_read_b128 v[48:51], v247 offset:7680
  s_mov_b64 exec, -1
  v_exp_f32 v68, v68
  v_exp_f32 v69, v69
  v_cvt_pk_bf16_f32 v52, v64, v65
  v_exp_f32 v70, v70
  v_cvt_pk_bf16_f32 v53, v66, v67
  v_exp_f32 v71, v71
  v_mfma_f32_32x32x8bf16_1k v[80:95], v[32:33], v[22:23], v[80:95]
  ds_read_b64 v[32:33], v245 offset:10240
  v_exp_f32 v72, v72
  v_cvt_pk_bf16_f32 v54, v68, v69
  v_exp_f32 v73, v73
  v_cvt_pk_bf16_f32 v55, v70, v71
  v_exp_f32 v74, v74
  v_exp_f32 v75, v75
  v_mfma_f32_32x32x16_bf16 v[96:111], v[36:39], v[52:55], v[96:111]
  v_exp_f32 v76, v76
  v_exp_f32 v77, v77
  v_cvt_pk_bf16_f32 v56, v72, v73
  v_exp_f32 v78, v78
  v_cvt_pk_bf16_f32 v57, v74, v75
  v_exp_f32 v79, v79
  v_cvt_pk_bf16_f32 v58, v76, v77
  v_cvt_pk_bf16_f32 v59, v78, v79
  s_waitcnt lgkmcnt(0)
  s_cmp_eq_u32 s35, 4
  s_cbranch_scc1 L_sw_p2_4
L_sw_p2_4_r:
  s_cmp_lg_u32 s55, 0
  s_cbranch_scc0 L_wo4
  s_mov_b32 m0, s39
  s_add_u32 s39, s39, 5120
  buffer_load_dwordx4 v254, s[12:15], s48 offen lds
  s_add_u32 s48, s48, 40960
  s_mov_b32 m0, s39
  s_add_u32 s39, s39, 5120
  buffer_load_dwordx4 v254, s[12:15], s48 offen lds
  s_add_u32 s48, s48, 40960
L_wo4:
  v_mfma_f32_32x32x16_bf16 v[64:79], v[28:31], v[16:19], v[128:143]
  ds_read2st64_b64 v[28:31], v244 offset0:25 offset1:26
  v_exp_f32 v80, v80
  v_exp_f32 v81, v81
  v_exp_f32 v82, v82
  v_exp_f32 v83, v83
  v_mfma_f32_32x32x16_bf16 v[96:111], v[40:43], v[56:59], v[96:111]
  s_mov_b64 exec, s[24:25]
  ds_read_b128 v[36:39], v246 offset:10240
  ds_read_b128 v[40:43], v247 offset:10240
  s_mov_b64 exec, -1
  v_exp_f32 v84, v84
  v_exp_f32 v85, v85
  v_cvt_pk_bf16_f32 v52, v80, v81
  v_exp_f32 v86, v86
  v_cvt_pk_bf16_f32 v53, v82, v83
  v_exp_f32 v87, v87
  v_mfma_f32_32x32x8bf16_1k v[64:79], v[32:33], v[22:23], v[64:79]
  ds_read_b64 v[32:33], v245 offset:12800
  v_exp_f32 v88, v88
  v_cvt_pk_bf16_f32 v54, v84, v85
  v_exp_f32 v89, v89
  v_cvt_pk_bf16_f32 v55, v86, v87
  v_exp_f32 v90, v90
  v_exp_f32 v91, v91
  v_mfma_f32_32x32x16_bf16 v[96:111], v[44:47], v[52:55], v[96:111]
  v_exp_f32 v92, v92
  v_exp_f32 v93, v93
  v_cvt_pk_bf16_f32 v56, v88, v89
  v_exp_f32 v94, v94
  v_cvt_pk_bf16_f32 v57, v90, v91
  v_exp_f32 v95, v95
  v_cvt_pk_bf16_f32 v58, v92, v93
  v_cvt_pk_bf16_f32 v59, v94, v95
  s_waitcnt lgkmcnt(0)
  s_cmp_eq_u32 s35, 5
  s_cbranch_scc1 L_sw_p2_5
L_sw_p2_5_r:
  s_cmp_lg_u32 s55, 0
  s_cbranch_scc0 L_wo5
  s_mov_b32 m0, s39
  s_add_u32 s39, s39, 5120
  buffer_load_dwordx4 v254, s[12:15], s48 offen lds
  s_add_u32 s48, s48, 40960
  s_mov_b32 m0, s39
  s_add_u32 s39, s39, 5120
  buffer_load_dwordx4 v254, s[12:15], s48 offen lds
  s_add_u32 s48, s48, 40960
L_wo5:
  v_mfma_f32_32x32x16_bf16 v[80:95], v[28:31], v[16:19], v[128:143]
  ds_read2st64_b64 v[28:31], v244 offset0:30 offset1:31
  v_exp_f32 v64, v64
  v_exp_f32 v65, v65
  v_exp_f32 v66, v66
  v_exp_f32 v67, v67
  v_mfma_f32_32x32x16_bf16 v[96:111], v[48:51], v[56:59], v[96:111]
  s_mov_b64 exec, s[24:25]
  ds_read_b128 v[44:47], v246 offset:12800
  ds_read_b128 v[48:51], v247 offset:12800
  s_mov_b64 exec, -1
  v_exp_f32 v68, v68
  v_exp_f32 v69, v69
  v_cvt_pk_bf16_f32 v52, v64, v65
  v_exp_f32 v70, v70
  v_cvt_pk_bf16_f32 v53, v66, v67
  v_exp_f32 v71, v71
  v_mfma_f32_32x32x8bf16_1k v[80:95], v[32:33], v[22:23], v[80:95]
  ds_read_b64 v[32:33], v245 offset:15360
  v_exp_f32 v72, v72
  v_cvt_pk_bf16_f32 v54, v68, v69
  v_exp_f32 v73, v73
  v_cvt_pk_bf16_f32 v55, v70, v71
  v_exp_f32 v74, v74
  v_exp_f32 v75, v75
  v_mfma_f32_32x32x16_bf16 v[96:111], v[36:39], v[52:55], v[96:111]
  v_exp_f32 v76, v76
  v_exp_f32 v77, v77
  v_cvt_pk_bf16_f32 v56, v72, v73
  v_exp_f32 v78, v78
  v_cvt_pk_bf16_f32 v57, v74, v75
  v_exp_f32 v79, v79
  v_cvt_pk_bf16_f32 v58, v76, v77
  v_cvt_pk_bf16_f32 v59, v78, v79
  s_waitcnt lgkmcnt(0)
  s_cmp_eq_u32 s35, 6
  s_cbranch_scc1 L_sw_p2_6
L_sw_p2_6_r:
  s_cmp_lg_u32 s55, 0
  s_cbranch_scc0 L_wo6
  s_mov_b32 m0, s39
  s_add_u32 s39, s39, 5120
  buffer_load_dwordx4 v254, s[12:15], s48 offen lds
  s_add_u32 s48, s48, 40960
  s_mov_b32 m0, s39
  s_add_u32 s39, s39, 5120
  buffer_load_dwordx4 v254, s[12:15], s48 offen lds
  s_add_u32 s48, s48, 40960
L_wo6:
  v_mfma_f32_32x32x16_bf16 v[64:79], v[28:31], v[16:19], v[128:143]
  ds_read2st64_b64 v[28:31], v244 offset0:35 offset1:36
  v_exp_f32 v80, v80
  v_exp_f32 v81, v81
  v_exp_f32 v82, v82
  v_exp_f32 v83, v83
  v_mfma_f32_32x32x16_bf16 v[96:111], v[40:43], v[56:59], v[96:111]
  s_mov_b64 exec, s[24:25]
  ds_read_b128 v[36:39], v246 offset:15360
  ds_read_b128 v[40:43], v247 offset:15360
  s_mov_b64 exec, -1
  v_exp_f32 v84, v84
  v_exp_f32 v85, v85
  v_cvt_pk_bf16_f32 v52, v80, v81
  v_exp_f32 v86, v86
  v_cvt_pk_bf16_f32 v53, v82, v83
  v_exp_f32 v87, v87
  v_mfma_f32_32x32x8bf16_1k v[64:79], v[32:33], v[22:23], v[64:79]
  ds_read_b64 v[32:33], v245 offset:17920
  v_exp_f32 v88, v88
  v_cvt_pk_bf16_f32 v54, v84, v85
  v_exp_f32 v89, v89
  v_cvt_pk_bf16_f32 v55, v86, v87
  v_exp_f32 v90, v90
  v_exp_f32 v91, v91
  v_mfma_f32_32x32x16_bf16 v[96:111], v[44:47], v[52:55], v[96:111]
  v_exp_f32 v92, v92
  v_exp_f32 v93, v93
  v_cvt_pk_bf16_f32 v56, v88, v89
  v_exp_f32 v94, v94
  v_cvt_pk_bf16_f32 v57, v90, v91
  v_exp_f32 v95, v95
  v_cvt_pk_bf16_f32 v58, v92, v93
  v_cvt_pk_bf16_f32 v59, v94, v95
  s_waitcnt lgkmcnt(0)
  s_cmp_eq_u32 s35, 7
  s_cbranch_scc1 L_sw_p2_7
L_sw_p2_7_r:
  s_cmp_lg_u32 s55, 0
  s_cbranch_scc0 L_wo7
  s_mov_b32 m0, s39
  s_add_u32 s39, s39, 5120
  buffer_load_dwordx4 v254, s[12:15], s48 offen lds
  s_add_u32 s48, s48, 40960
  s_mov_b32 m0, s39
  s_add_u32 s39, s39, 5120
  buffer_load_dwordx4 v254, s[12:15], s48 offen lds
  s_add_u32 s48, s48, 40960
L_wo7:
  v_mfma_f32_32x32x16_bf16 v[80:95], v[28:31], v[16:19], v[128:143]
  ds_read2st64_b64 v[28:31], v244 offset0:40 offset1:41
  v_exp_f32 v64, v64
  v_exp_f32 v65, v65
  v_exp_f32 v66, v66
  v_exp_f32 v67, v67
  v_mfma_f32_32x32x16_bf16 v[96:111], v[48:51], v[56:59], v[96:111]
  s_mov_b64 exec, s[24:25]
  ds_read_b128 v[44:47], v246 offset:17920
  ds_read_b128 v[48:51], v247 offset:17920
  s_mov_b64 exec, -1
  v_exp_f32 v68, v68
  v_exp_f32 v69, v69
  v_cvt_pk_bf16_f32 v52, v64, v65
  v_exp_f32 v70, v70
  v_cvt_pk_bf16_f32 v53, v66, v67
  v_exp_f32 v71, v71
  v_mfma_f32_32x32x8bf16_1k v[80:95], v[32:33], v[22:23], v[80:95]
  ds_read_b64 v[32:33], v245 offset:20480
  v_exp_f32 v72, v72
  v_cvt_pk_bf16_f32 v54, v68, v69
  v_exp_f32 v73, v73
  v_cvt_pk_bf16_f32 v55, v70, v71
  v_exp_f32 v74, v74
  v_exp_f32 v75, v75
  v_mfma_f32_32x32x16_bf16 v[96:111], v[36:39], v[52:55], v[96:111]
  v_exp_f32 v76, v76
  v_exp_f32 v77, v77
  v_cvt_pk_bf16_f32 v56, v72, v73
  v_exp_f32 v78, v78
  v_cvt_pk_bf16_f32 v57, v74, v75
  v_exp_f32 v79, v79
  v_cvt_pk_bf16_f32 v58, v76, v77
  v_cvt_pk_bf16_f32 v59, v78, v79
  s_waitcnt lgkmcnt(0)
  s_cmp_lg_u32 s55, 0
  s_cbranch_scc0 L_wo8
  s_mov_b32 m0, s39
  s_add_u32 s39, s39, 5120
  buffer_load_dwordx4 v254, s[12:15], s48 offen lds
  s_add_u32 s48, s48, 40960
  s_mov_b32 m0, s39
  s_add_u32 s39, s39, 5120
  buffer_load_dwordx4 v254, s[12:15], s48 offen lds
  s_add_u32 s48, s48, 40960
L_wo8:
  v_mfma_f32_32x32x16_bf16 v[64:79], v[28:31], v[16:19], v[228:243]
  v_exp_f32 v80, v80
  v_exp_f32 v81, v81
  v_exp_f32 v82, v82
  v_exp_f32 v83, v83
  v_mfma_f32_32x32x16_bf16 v[96:111], v[40:43], v[56:59], v[96:111]
  s_mov_b64 exec, s[24:25]
  ds_read_b128 v[36:39], v246 offset:20480
  ds_read_b128 v[40:43], v247 offset:20480
  s_mov_b64 exec, -1
  v_exp_f32 v84, v84
  v_exp_f32 v85, v85
  v_cvt_pk_bf16_f32 v52, v80, v81
  v_exp_f32 v86, v86
  v_cvt_pk_bf16_f32 v53, v82, v83
  v_exp_f32 v87, v87
  v_mfma_f32_32x32x8bf16_1k v[64:79], v[32:33], v[22:23], v[64:79]
  v_exp_f32 v88, v88
  v_cvt_pk_bf16_f32 v54, v84, v85
  v_exp_f32 v89, v89
  v_cvt_pk_bf16_f32 v55, v86, v87
  v_exp_f32 v90, v90
  v_exp_f32 v91, v91
  v_mfma_f32_32x32x16_bf16 v[96:111], v[44:47], v[52:55], v[96:111]
  v_exp_f32 v92, v92
  v_exp_f32 v93, v93
  v_cvt_pk_bf16_f32 v56, v88, v89
  v_exp_f32 v94, v94
  v_cvt_pk_bf16_f32 v57, v90, v91
  v_exp_f32 v95, v95
  v_cvt_pk_bf16_f32 v58, v92, v93
  v_cvt_pk_bf16_f32 v59, v94, v95
  s_waitcnt lgkmcnt(0)
  s_cmp_lg_u32 s55, 0
  s_cbranch_scc0 L_wo9
  s_mov_b32 m0, s39
  s_add_u32 s39, s39, 5120
  buffer_load_dwordx4 v254, s[12:15], s48 offen lds
  s_add_u32 s48, s48, 40960
  s_mov_b32 m0, s39
  s_add_u32 s39, s39, 5120
  buffer_load_dwordx4 v254, s[12:15], s48 offen lds
  s_add_u32 s48, s48, 40960
L_wo9:
  v_exp_f32 v64, v64
  v_exp_f32 v65, v65
  v_exp_f32 v66, v66
  v_exp_f32 v67, v67
  v_mfma_f32_32x32x16_bf16 v[96:111], v[48:51], v[56:59], v[96:111]
  v_exp_f32 v68, v68
  v_exp_f32 v69, v69
  v_cvt_pk_bf16_f32 v52, v64, v65
  v_exp_f32 v70, v70
  v_cvt_pk_bf16_f32 v53, v66, v67
  v_exp_f32 v71, v71
  v_exp_f32 v72, v72
  v_cvt_pk_bf16_f32 v54, v68, v69
  v_exp_f32 v73, v73
  v_cvt_pk_bf16_f32 v55, v70, v71
  v_exp_f32 v74, v74
  v_exp_f32 v75, v75
  v_mfma_f32_32x32x16_bf16 v[96:111], v[36:39], v[52:55], v[96:111]
  v_exp_f32 v76, v76
  v_exp_f32 v77, v77
  v_cvt_pk_bf16_f32 v56, v72, v73
  v_exp_f32 v78, v78
  v_cvt_pk_bf16_f32 v57, v74, v75
  v_exp_f32 v79, v79
  v_cvt_pk_bf16_f32 v58, v76, v77
  v_cvt_pk_bf16_f32 v59, v78, v79
  s_nop 1
  v_mfma_f32_32x32x16_bf16 v[96:111], v[40:43], v[56:59], v[96:111]
  s_nop 15
  s_nop 0
  v_mov_b32 v3, v104
  v_mov_b32 v4, v104
  s_nop 1
  v_permlane32_swap_b32 v3, v4
  s_nop 1
  v_max3_f32 v5, |v96|, |v97|, |v98|
  v_max3_f32 v5, v5, |v99|, |v100|
  v_max3_f32 v5, v5, |v101|, |v102|
  v_max3_f32 v5, v5, |v103|, |v104|
  v_max3_f32 v5, v5, |v105|, |v106|
  v_max_f32_e64 v5, v5, |v107|
  v_mul_f32 v5, 0x32000000, v5
  v_max_f32 v5, v5, v4
  v_mov_b32 v14, 0x71800000
  v_cmp_nlt_f32 vcc, v5, v14
  v_cmp_u_f32 s[56:57], v4, v4
  s_nop 4
  s_or_b64 vcc, vcc, s[56:57]
  s_cbranch_vccnz L_a_exact
L_a_store:
  v_rcp_f32 v5, v4
  s_lshr_b32 s20, s16, 1
  s_lshl_b32 s20, s20, 10
  s_and_b32 s21, s16, 1
  s_lshl_b32 s21, s21, 9
  s_add_u32 s20, s20, s21
  s_add_u32 s20, s20, s50
  v_mul_f32 v96, v96, v5
  v_mul_f32 v97, v97, v5
  v_mul_f32 v98, v98, v5
  v_mul_f32 v99, v99, v5
  v_mul_f32 v100, v100, v5
  v_mul_f32 v101, v101, v5
  v_mul_f32 v102, v102, v5
  v_mul_f32 v103, v103, v5
  v_mul_f32 v104, v104, v5
  v_mul_f32 v105, v105, v5
  v_mul_f32 v106, v106, v5
  v_mul_f32 v107, v107, v5
  v_cvt_pk_bf16_f32 v64, v96, v97
  v_cvt_pk_bf16_f32 v65, v98, v99
  v_cvt_pk_bf16_f32 v66, v100, v101
  v_cvt_pk_bf16_f32 v67, v102, v103
  v_cvt_pk_bf16_f32 v68, v104, v105
  v_cvt_pk_bf16_f32 v69, v106, v107
  buffer_store_dwordx4 v[64:67], v250, s[8:11], s20 offen sc1
  s_lshl_b32 s20, s16, 7
  s_add_u32 s20, s20, s51
  s_mov_b64 exec, s[26:27]
  buffer_store_dwordx2 v[68:69], v251, s[8:11], s20 offen sc1
  s_mov_b64 exec, -1
  s_waitcnt vmcnt(0)
  s_barrier
  s_cmp_lg_u32 s97, 4
  s_cbranch_scc1 L_p3
  s_lshl_b32 s20, s17, 12
  s_lshl_b32 s21, s16, 7
  s_add_u32 s20, s20, s21
  s_add_u32 s20, s20, 65536
  s_add_u32 s20, s20, 20971520
  s_mov_b64 exec, 1
  v_mov_b32 v2, s20
  v_mov_b32 v3, s59
  global_store_dword v2, v3, s[100:101] sc1
  s_mov_b64 exec, -1
  s_and_b32 s20, s96, 3
  s_lshl_b32 s20, s20, 1
  s_lshr_b32 s21, s96, 7
  s_add_u32 s20, s20, s21
  s_lshl_b32 s20, s20, 12
  s_add_u32 s20, s20, 21037056
  v_and_b32 v2, 31, v1
  v_lshlrev_b32 v2, 7, v2
  v_add_u32 v2, s20, v2
  s_mov_b32 s58, 0x40000
L_poll_p3:
  global_load_dword v3, v2, s[100:101] offset:0 sc1
  s_waitcnt vmcnt(0)
  v_cmp_eq_u32 s[56:57], s59, v3
  s_nop 4
  s_and_b32 s56, s56, 0xffffffff
  s_and_b32 s57, s57, 0x0
  s_cmp_lg_u32 s56, 0xffffffff
  s_cbranch_scc1 L_polln_p3
  s_cmp_eq_u32 s57, 0x0
  s_cbranch_scc1 L_polld_p3
L_polln_p3:
  s_sleep 2
  s_sub_u32 s58, s58, 1
  s_cmp_lg_u32 s58, 0
  s_cbranch_scc1 L_poll_p3
L_polld_p3:
  s_barrier
  s_branch L_done
L_a_exact:
  s_cmp_lg_u32 s30, 0
  s_cbranch_scc1 L_a_store
  s_mov_b32 s30, 1
  s_mov_b32 s55, 0
  v_sub_f32 v212, v212, v10
  v_sub_f32 v213, v213, v10
  v_sub_f32 v214, v214, v10
  v_sub_f32 v215, v215, v10
  v_sub_f32 v216, v216, v10
  v_sub_f32 v217, v217, v10
  v_sub_f32 v218, v218, v10
  v_sub_f32 v219, v219, v10
  v_sub_f32 v220, v220, v10
  v_sub_f32 v221, v221, v10
  v_sub_f32 v222, v222, v10
  v_sub_f32 v223, v223, v10
  v_sub_f32 v224, v224, v10
  v_sub_f32 v225, v225, v10
  v_sub_f32 v226, v226, v10
  v_sub_f32 v227, v227, v10
  v_sub_f32 v228, v228, v10
  v_sub_f32 v229, v229, v10
  v_sub_f32 v230, v230, v10
  v_sub_f32 v231, v231, v10
  v_sub_f32 v232, v232, v10
  v_sub_f32 v233, v233, v10
  v_sub_f32 v234, v234, v10
  v_sub_f32 v235, v235, v10
  v_sub_f32 v236, v236, v10
  v_sub_f32 v237, v237, v10
  v_sub_f32 v238, v238, v10
  v_sub_f32 v239, v239, v10
  v_sub_f32 v240, v240, v10
  v_sub_f32 v241, v241, v10
  v_sub_f32 v242, v242, v10
  v_sub_f32 v243, v243, v10
  s_cmp_le_u32 s35, 1
  s_cbranch_scc1 L_cm_p1x_v
  v_mov_b32 v128, 0xf149f2ca
  v_mov_b32 v129, 0xf149f2ca
  v_mov_b32 v130, 0xf149f2ca
  v_mov_b32 v131, 0xf149f2ca
  v_mov_b32 v132, 0xf149f2ca
  v_mov_b32 v133, 0xf149f2ca
  v_mov_b32 v134, 0xf149f2ca
  v_mov_b32 v135, 0xf149f2ca
  v_mov_b32 v136, 0xf149f2ca
  v_mov_b32 v137, 0xf149f2ca
  v_mov_b32 v138, 0xf149f2ca
  v_mov_b32 v139, 0xf149f2ca
  v_mov_b32 v140, 0xf149f2ca
  v_mov_b32 v141, 0xf149f2ca
  v_mov_b32 v142, 0xf149f2ca
  v_mov_b32 v143, 0xf149f2ca
  s_branch L_cm_p1x_d
L_cm_p1x_v:
  v_mov_b32 v128, 0
  v_mov_b32 v129, 0
  v_mov_b32 v130, 0
  v_mov_b32 v131, 0
  v_mov_b32 v132, 0
  v_mov_b32 v133, 0
  v_mov_b32 v134, 0
  v_mov_b32 v135, 0
  v_mov_b32 v136, 0
  v_mov_b32 v137, 0
  v_mov_b32 v138, 0
  v_mov_b32 v139, 0
  v_mov_b32 v140, 0
  v_mov_b32 v141, 0
  v_mov_b32 v142, 0
  v_mov_b32 v143, 0
L_cm_p1x_d:
  ds_read2st64_b64 v[36:39], v244 offset0:0 offset1:1
  ds_read_b64 v[40:41], v245 offset:0
  ds_read2st64_b64 v[44:47], v244 offset0:5 offset1:6
  ds_read_b64 v[48:49], v245 offset:2560
  ds_read2st64_b64 v[52:55], v244 offset0:10 offset1:11
  ds_read_b64 v[56:57], v245 offset:5120
  s_waitcnt lgkmcnt(0)
  v_mfma_f32_32x32x16_bf16 v[64:79], v[36:39], v[16:19], v[212:227]
  v_mfma_f32_32x32x8bf16_1k v[64:79], v[40:41], v[22:23], v[64:79]
  v_mfma_f32_32x32x16_bf16 v[80:95], v[44:47], v[16:19], v[128:143]
  v_mfma_f32_32x32x8bf16_1k v[80:95], v[48:49], v[22:23], v[80:95]
  s_cmp_eq_u32 s35, 2
  s_cbranch_scc1 L_sw_p1x_2
L_sw_p1x_2_r:
  v_mfma_f32_32x32x16_bf16 v[96:111], v[52:55], v[16:19], v[128:143]
  v_mfma_f32_32x32x8bf16_1k v[96:111], v[56:57], v[22:23], v[96:111]
  ds_read2st64_b64 v[36:39], v244 offset0:15 offset1:16
  ds_read_b64 v[40:41], v245 offset:7680
  ds_read2st64_b64 v[44:47], v244 offset0:20 offset1:21
  ds_read_b64 v[48:49], v245 offset:10240
  ds_read2st64_b64 v[52:55], v244 offset0:25 offset1:26
  ds_read_b64 v[56:57], v245 offset:12800
  s_nop 7
  v_max3_f32 v10, v64, v65, v66
  v_max3_f32 v10, v10, v67, v68
  v_max3_f32 v10, v10, v69, v70
  v_max3_f32 v10, v10, v71, v72
  v_max3_f32 v10, v10, v73, v74
  v_max3_f32 v10, v10, v75, v76
  v_max3_f32 v10, v10, v77, v78
  v_max_f32 v10, v10, v79
  v_max3_f32 v10, v10, v80, v81
  v_max3_f32 v10, v10, v82, v83
  v_max3_f32 v10, v10, v84, v85
  v_max3_f32 v10, v10, v86, v87
  v_max3_f32 v10, v10, v88, v89
  v_max3_f32 v10, v10, v90, v91
  v_max3_f32 v10, v10, v92, v93
  v_max3_f32 v10, v10, v94, v95
  s_nop 3
  v_max3_f32 v10, v10, v96, v97
  v_max3_f32 v10, v10, v98, v99
  v_max3_f32 v10, v10, v100, v101
  v_max3_f32 v10, v10, v102, v103
  v_max3_f32 v10, v10, v104, v105
  v_max3_f32 v10, v10, v106, v107
  v_max3_f32 v10, v10, v108, v109
  v_max3_f32 v10, v10, v110, v111
  s_waitcnt lgkmcnt(0)
  s_cmp_eq_u32 s35, 3
  s_cbranch_scc1 L_sw_p1x_3
L_sw_p1x_3_r:
  v_mfma_f32_32x32x16_bf16 v[64:79], v[36:39], v[16:19], v[128:143]
  v_mfma_f32_32x32x8bf16_1k v[64:79], v[40:41], v[22:23], v[64:79]
  s_cmp_eq_u32 s35, 4
  s_cbranch_scc1 L_sw_p1x_4
L_sw_p1x_4_r:
  v_mfma_f32_32x32x16_bf16 v[80:95], v[44:47], v[16:19], v[128:143]
  v_mfma_f32_32x32x8bf16_1k v[80:95], v[48:49], v[22:23], v[80:95]
  s_cmp_eq_u32 s35, 5
  s_cbranch_scc1 L_sw_p1x_5
L_sw_p1x_5_r:
  v_mfma_f32_32x32x16_bf16 v[96:111], v[52:55], v[16:19], v[128:143]
  v_mfma_f32_32x32x8bf16_1k v[96:111], v[56:57], v[22:23], v[96:111]
  ds_read2st64_b64 v[36:39], v244 offset0:30 offset1:31
  ds_read_b64 v[40:41], v245 offset:15360
  ds_read2st64_b64 v[44:47], v244 offset0:35 offset1:36
  ds_read_b64 v[48:49], v245 offset:17920
  ds_read2st64_b64 v[52:55], v244 offset0:40 offset1:41
  ds_read_b64 v[56:57], v245 offset:20480
  s_nop 7
  v_max3_f32 v10, v10, v64, v65
  v_max3_f32 v10, v10, v66, v67
  v_max3_f32 v10, v10, v68, v69
  v_max3_f32 v10, v10, v70, v71
  v_max3_f32 v10, v10, v72, v73
  v_max3_f32 v10, v10, v74, v75
  v_max3_f32 v10, v10, v76, v77
  v_max3_f32 v10, v10, v78, v79
  v_max3_f32 v10, v10, v80, v81
  v_max3_f32 v10, v10, v82, v83
  v_max3_f32 v10, v10, v84, v85
  v_max3_f32 v10, v10, v86, v87
  v_max3_f32 v10, v10, v88, v89
  v_max3_f32 v10, v10, v90, v91
  v_max3_f32 v10, v10, v92, v93
  v_max3_f32 v10, v10, v94, v95
  s_nop 3
  v_max3_f32 v10, v10, v96, v97
  v_max3_f32 v10, v10, v98, v99
  v_max3_f32 v10, v10, v100, v101
  v_max3_f32 v10, v10, v102, v103
  v_max3_f32 v10, v10, v104, v105
  v_max3_f32 v10, v10, v106, v107
  v_max3_f32 v10, v10, v108, v109
  v_max3_f32 v10, v10, v110, v111
  s_waitcnt lgkmcnt(0)
  s_cmp_eq_u32 s35, 6
  s_cbranch_scc1 L_sw_p1x_6
L_sw_p1x_6_r:
  v_mfma_f32_32x32x16_bf16 v[64:79], v[36:39], v[16:19], v[128:143]
  v_mfma_f32_32x32x8bf16_1k v[64:79], v[40:41], v[22:23], v[64:79]
  s_cmp_eq_u32 s35, 7
  s_cbranch_scc1 L_sw_p1x_7
L_sw_p1x_7_r:
  v_mfma_f32_32x32x16_bf16 v[80:95], v[44:47], v[16:19], v[128:143]
  v_mfma_f32_32x32x8bf16_1k v[80:95], v[48:49], v[22:23], v[80:95]
  v_mfma_f32_32x32x16_bf16 v[96:111], v[52:55], v[16:19], v[228:243]
  v_mfma_f32_32x32x8bf16_1k v[96:111], v[56:57], v[22:23], v[96:111]
  ds_read2st64_b64 v[28:31], v244 offset0:0 offset1:1
  ds_read_b64 v[32:33], v245 offset:0
  s_nop 7
  v_max3_f32 v10, v10, v64, v65
  v_max3_f32 v10, v10, v66, v67
  v_max3_f32 v10, v10, v68, v69
  v_max3_f32 v10, v10, v70, v71
  v_max3_f32 v10, v10, v72, v73
  v_max3_f32 v10, v10, v74, v75
  v_max3_f32 v10, v10, v76, v77
  v_max3_f32 v10, v10, v78, v79
  v_max3_f32 v10, v10, v80, v81
  v_max3_f32 v10, v10, v82, v83
  v_max3_f32 v10, v10, v84, v85
  v_max3_f32 v10, v10, v86, v87
  v_max3_f32 v10, v10, v88, v89
  v_max3_f32 v10, v10, v90, v91
  v_max3_f32 v10, v10, v92, v93
  v_max3_f32 v10, v10, v94, v95
  s_nop 3
  v_max3_f32 v10, v10, v96, v97
  v_max3_f32 v10, v10, v98, v99
  v_max3_f32 v10, v10, v100, v101
  v_max3_f32 v10, v10, v102, v103
  v_max3_f32 v10, v10, v104, v105
  v_max3_f32 v10, v10, v106, v107
  v_max3_f32 v10, v10, v108, v109
  v_max3_f32 v10, v10, v110, v111
  s_branch L_a_p2
L_bb0:
  s_waitcnt vmcnt(4)
  s_barrier
  s_cmp_lg_u32 s97, 4
  s_cbranch_scc1 L_bb_r
  s_cmp_lt_i32 s49, 0
  s_cbranch_scc0 L_bb_r
  s_and_b32 s50, s49, 0x7fffffff
  s_add_u32 s50, s50, 20971520
  s_mov_b64 exec, 1
  v_mov_b32 v2, s50
  v_mov_b32 v3, s59
  global_store_dword v2, v3, s[100:101] sc1
  s_mov_b64 exec, -1
  s_branch L_bb_r
L_bb2:
  s_cmp_lg_u32 s97, 0
  s_cbranch_scc1 L_bb2a
  s_mov_b32 s58, 0x40000
  v_mov_b32 v2, 0
L_tok_a:
  global_load_dword v3, v2, s[98:99] sc1
  s_waitcnt vmcnt(0)
  v_readfirstlane_b32 s59, v3
  s_nop 3
  s_cmp_lg_u32 s59, 0
  s_cbranch_scc1 L_tokd_a
  s_sleep 4
  s_sub_u32 s58, s58, 1
  s_cmp_lg_u32 s58, 0
  s_cbranch_scc1 L_tok_a
L_tokd_a:
  s_and_b32 s52, s96, 7
  s_lshr_b32 s53, s96, 3
  s_lshl_b32 s50, s52, 2
  s_lshr_b32 s52, s53, 3
  s_add_u32 s50, s50, s52
  s_and_b32 s51, s53, 7
  s_mul_i32 s50, s50, 20
  s_lshr_b32 s51, s50, 7
  s_add_u32 s50, s50, 19
  s_lshr_b32 s50, s50, 7
  s_sub_u32 s50, s50, s51
  v_bfe_u32 v2, v1, 4, 1
  v_mul_u32_u24 v2, s50, v2
  v_add_u32 v2, s51, v2
  v_lshrrev_b32 v5, 5, v1
  v_mul_u32_u24 v5, 5, v5
  v_add_u32 v5, v5, v2
  v_add_u32 v14, 10, v2
  v_and_b32 v2, 15, v1
  v_lshl_add_u32 v5, v5, 4, v2
  v_lshl_add_u32 v14, v14, 4, v2
  v_lshlrev_b32 v5, 7, v5
  v_lshlrev_b32 v14, 7, v14
  v_add_u32 v5, 20971520, v5
  v_add_u32 v14, 20971520, v14
  s_mov_b32 s58, 0x40000
L_poll_a:
  global_load_dword v3, v5, s[100:101] sc1
  global_load_dword v4, v14, s[100:101] sc1
  s_waitcnt vmcnt(0)
  v_cmp_eq_u32 s[56:57], s59, v3
  v_cmp_eq_u32 vcc, s59, v4
  s_nop 4
  s_and_b64 s[56:57], s[56:57], vcc
  s_and_b32 s56, s56, 0xffffffff
  s_and_b32 s57, s57, 0xffffffff
  s_cmp_lg_u32 s56, 0xffffffff
  s_cbranch_scc1 L_polln_a
  s_cmp_eq_u32 s57, 0xffffffff
  s_cbranch_scc1 L_polld_a
L_polln_a:
  s_sleep 1
  s_sub_u32 s58, s58, 1
  s_cmp_lg_u32 s58, 0
  s_cbranch_scc1 L_poll_a
L_polld_a:
L_bb2a:
  s_waitcnt vmcnt(0)
  s_barrier
  s_add_u32 s44, s100, s36
  s_addc_u32 s45, s101, 0
  s_and_b32 s45, s45, 0xffff
  s_mov_b32 s46, 40960
  s_lshl_b32 s31, s97, 10
  s_sub_u32 s31, s31, 24576
  s_mov_b32 m0, s31
  s_mov_b32 s32, 8192
  s_mov_b32 s33, 8192
  buffer_load_dwordx2 v[192:193], v252, s[4:7], s34 offen
  buffer_load_dwordx2 v[194:195], v252, s[4:7], s34 offen offset:512
  buffer_load_dwordx2 v[60:61], v253, s[4:7], s34 offen
  s_branch L_bb_r
L_sw_p1_7:
  s_nop 15
  v_mov_b32 v128, 0
  v_mov_b32 v129, 0
  v_mov_b32 v130, 0
  v_mov_b32 v131, 0
  v_mov_b32 v132, 0
  v_mov_b32 v133, 0
  v_mov_b32 v134, 0
  v_mov_b32 v135, 0
  v_mov_b32 v136, 0
  v_mov_b32 v137, 0
  v_mov_b32 v138, 0
  v_mov_b32 v139, 0
  v_mov_b32 v140, 0
  v_mov_b32 v141, 0
  v_mov_b32 v142, 0
  v_mov_b32 v143, 0
  s_nop 1
  s_branch L_sw_p1_7_r
L_sw_p2_2:
  s_nop 15
  v_mov_b32 v128, v10
  v_mov_b32 v129, v10
  v_mov_b32 v130, v10
  v_mov_b32 v131, v10
  v_mov_b32 v132, v10
  v_mov_b32 v133, v10
  v_mov_b32 v134, v10
  v_mov_b32 v135, v10
  v_mov_b32 v136, v10
  v_mov_b32 v137, v10
  v_mov_b32 v138, v10
  v_mov_b32 v139, v10
  v_mov_b32 v140, v10
  v_mov_b32 v141, v10
  v_mov_b32 v142, v10
  v_mov_b32 v143, v10
  s_nop 1
  s_branch L_sw_p2_2_r
L_sw_p2_3:
  s_nop 15
  v_mov_b32 v128, v10
  v_mov_b32 v129, v10
  v_mov_b32 v130, v10
  v_mov_b32 v131, v10
  v_mov_b32 v132, v10
  v_mov_b32 v133, v10
  v_mov_b32 v134, v10
  v_mov_b32 v135, v10
  v_mov_b32 v136, v10
  v_mov_b32 v137, v10
  v_mov_b32 v138, v10
  v_mov_b32 v139, v10
  v_mov_b32 v140, v10
  v_mov_b32 v141, v10
  v_mov_b32 v142, v10
  v_mov_b32 v143, v10
  s_nop 1
  s_branch L_sw_p2_3_r
L_sw_p2_4:
  s_nop 15
  v_mov_b32 v128, v10
  v_mov_b32 v129, v10
  v_mov_b32 v130, v10
  v_mov_b32 v131, v10
  v_mov_b32 v132, v10
  v_mov_b32 v133, v10
  v_mov_b32 v134, v10
  v_mov_b32 v135, v10
  v_mov_b32 v136, v10
  v_mov_b32 v137, v10
  v_mov_b32 v138, v10
  v_mov_b32 v139, v10
  v_mov_b32 v140, v10
  v_mov_b32 v141, v10
  v_mov_b32 v142, v10
  v_mov_b32 v143, v10
  s_nop 1
  s_branch L_sw_p2_4_r
L_sw_p2_5:
  s_nop 15
  v_mov_b32 v128, v10
  v_mov_b32 v129, v10
  v_mov_b32 v130, v10
  v_mov_b32 v131, v10
  v_mov_b32 v132, v10
  v_mov_b32 v133, v10
  v_mov_b32 v134, v10
  v_mov_b32 v135, v10
  v_mov_b32 v136, v10
  v_mov_b32 v137, v10
  v_mov_b32 v138, v10
  v_mov_b32 v139, v10
  v_mov_b32 v140, v10
  v_mov_b32 v141, v10
  v_mov_b32 v142, v10
  v_mov_b32 v143, v10
  s_nop 1
  s_branch L_sw_p2_5_r
L_sw_p2_6:
  s_nop 15
  v_mov_b32 v128, v10
  v_mov_b32 v129, v10
  v_mov_b32 v130, v10
  v_mov_b32 v131, v10
  v_mov_b32 v132, v10
  v_mov_b32 v133, v10
  v_mov_b32 v134, v10
  v_mov_b32 v135, v10
  v_mov_b32 v136, v10
  v_mov_b32 v137, v10
  v_mov_b32 v138, v10
  v_mov_b32 v139, v10
  v_mov_b32 v140, v10
  v_mov_b32 v141, v10
  v_mov_b32 v142, v10
  v_mov_b32 v143, v10
  s_nop 1
  s_branch L_sw_p2_6_r
L_sw_p2_7:
  s_nop 15
  v_mov_b32 v128, v10
  v_mov_b32 v129, v10
  v_mov_b32 v130, v10
  v_mov_b32 v131, v10
  v_mov_b32 v132, v10
  v_mov_b32 v133, v10
  v_mov_b32 v134, v10
  v_mov_b32 v135, v10
  v_mov_b32 v136, v10
  v_mov_b32 v137, v10
  v_mov_b32 v138, v10
  v_mov_b32 v139, v10
  v_mov_b32 v140, v10
  v_mov_b32 v141, v10
  v_mov_b32 v142, v10
  v_mov_b32 v143, v10
  s_nop 1
  s_branch L_sw_p2_7_r
L_sw_p1x_2:
  s_nop 15
  v_mov_b32 v128, 0
  v_mov_b32 v129, 0
  v_mov_b32 v130, 0
  v_mov_b32 v131, 0
  v_mov_b32 v132, 0
  v_mov_b32 v133, 0
  v_mov_b32 v134, 0
  v_mov_b32 v135, 0
  v_mov_b32 v136, 0
  v_mov_b32 v137, 0
  v_mov_b32 v138, 0
  v_mov_b32 v139, 0
  v_mov_b32 v140, 0
  v_mov_b32 v141, 0
  v_mov_b32 v142, 0
  v_mov_b32 v143, 0
  s_nop 1
  s_branch L_sw_p1x_2_r
L_sw_p1x_3:
  s_nop 15
  v_mov_b32 v128, 0
  v_mov_b32 v129, 0
  v_mov_b32 v130, 0
  v_mov_b32 v131, 0
  v_mov_b32 v132, 0
  v_mov_b32 v133, 0
  v_mov_b32 v134, 0
  v_mov_b32 v135, 0
  v_mov_b32 v136, 0
  v_mov_b32 v137, 0
  v_mov_b32 v138, 0
  v_mov_b32 v139, 0
  v_mov_b32 v140, 0
  v_mov_b32 v141, 0
  v_mov_b32 v142, 0
  v_mov_b32 v143, 0
  s_nop 1
  s_branch L_sw_p1x_3_r
L_sw_p1x_4:
  s_nop 15
  v_mov_b32 v128, 0
  v_mov_b32 v129, 0
  v_mov_b32 v130, 0
  v_mov_b32 v131, 0
  v_mov_b32 v132, 0
  v_mov_b32 v133, 0
  v_mov_b32 v134, 0
  v_mov_b32 v135, 0
  v_mov_b32 v136, 0
  v_mov_b32 v137, 0
  v_mov_b32 v138, 0
  v_mov_b32 v139, 0
  v_mov_b32 v140, 0
  v_mov_b32 v141, 0
  v_mov_b32 v142, 0
  v_mov_b32 v143, 0
  s_nop 1
  s_branch L_sw_p1x_4_r
L_sw_p1x_5:
  s_nop 15
  v_mov_b32 v128, 0
  v_mov_b32 v129, 0
  v_mov_b32 v130, 0
  v_mov_b32 v131, 0
  v_mov_b32 v132, 0
  v_mov_b32 v133, 0
  v_mov_b32 v134, 0
  v_mov_b32 v135, 0
  v_mov_b32 v136, 0
  v_mov_b32 v137, 0
  v_mov_b32 v138, 0
  v_mov_b32 v139, 0
  v_mov_b32 v140, 0
  v_mov_b32 v141, 0
  v_mov_b32 v142, 0
  v_mov_b32 v143, 0
  s_nop 1
  s_branch L_sw_p1x_5_r
L_sw_p1x_6:
  s_nop 15
  v_mov_b32 v128, 0
  v_mov_b32 v129, 0
  v_mov_b32 v130, 0
  v_mov_b32 v131, 0
  v_mov_b32 v132, 0
  v_mov_b32 v133, 0
  v_mov_b32 v134, 0
  v_mov_b32 v135, 0
  v_mov_b32 v136, 0
  v_mov_b32 v137, 0
  v_mov_b32 v138, 0
  v_mov_b32 v139, 0
  v_mov_b32 v140, 0
  v_mov_b32 v141, 0
  v_mov_b32 v142, 0
  v_mov_b32 v143, 0
  s_nop 1
  s_branch L_sw_p1x_6_r
L_sw_p1x_7:
  s_nop 15
  v_mov_b32 v128, 0
  v_mov_b32 v129, 0
  v_mov_b32 v130, 0
  v_mov_b32 v131, 0
  v_mov_b32 v132, 0
  v_mov_b32 v133, 0
  v_mov_b32 v134, 0
  v_mov_b32 v135, 0
  v_mov_b32 v136, 0
  v_mov_b32 v137, 0
  v_mov_b32 v138, 0
  v_mov_b32 v139, 0
  v_mov_b32 v140, 0
  v_mov_b32 v141, 0
  v_mov_b32 v142, 0
  v_mov_b32 v143, 0
  s_nop 1
  s_branch L_sw_p1x_7_r
L_b_fallback:
  v_mov_b32 v14, v20
  v_mov_b32 v15, v20
  s_nop 1
  v_permlane32_swap_b32 v14, v15
  s_cmp_eq_u32 s19, 0
  s_cselect_b64 s[56:57], -1, 0
  s_nop 1
  v_cndmask_b32 v14, v15, v14, s[56:57]
  v_cndmask_b32 v22, 0, v14, s[26:27]
  v_mov_b32 v14, v21
  v_mov_b32 v15, v21
  s_nop 1
  v_permlane32_swap_b32 v14, v15
  s_cmp_eq_u32 s19, 0
  s_cselect_b64 s[56:57], -1, 0
  s_nop 1
  v_cndmask_b32 v14, v15, v14, s[56:57]
  v_cndmask_b32 v23, 0, v14, s[26:27]
  v_lshlrev_b32 v14, 3, v249
  v_add_u32 v14, 1024, v14
  v_lshrrev_b32 v2, 5, v1
  v_bfe_u32 v15, v249, 2, 2
  v_xor_b32 v15, v15, v2
  v_lshlrev_b32 v15, 4, v15
  v_lshl_add_u32 v15, v249, 6, v15
  v_add_u32 v15, 1280, v15
  v_xor_b32 v2, 32, v15
  v_mov_b32 v10, 0xf149f2ca
  s_mov_b32 s20, s29
  s_mov_b32 s28, 64
L_fb_p1:
  buffer_load_dwordx2 v[28:29], v252, s[4:7], s20 offen
  buffer_load_dwordx2 v[30:31], v252, s[4:7], s20 offen offset:512
  buffer_load_dwordx2 v[32:33], v14, s[4:7], s20 offen
  s_waitcnt vmcnt(0)
  v_mfma_f32_32x32x16_bf16 v[64:79], v[28:31], v[16:19], 0
  v_mfma_f32_32x32x8bf16_1k v[64:79], v[32:33], v[22:23], v[64:79]
  s_nop 15
  v_max3_f32 v10, v10, v64, v65
  v_max3_f32 v10, v10, v66, v67
  v_max3_f32 v10, v10, v68, v69
  v_max3_f32 v10, v10, v70, v71
  v_max3_f32 v10, v10, v72, v73
  v_max3_f32 v10, v10, v74, v75
  v_max3_f32 v10, v10, v76, v77
  v_max3_f32 v10, v10, v78, v79
  s_add_u32 s20, s20, 2560
  s_sub_u32 s28, s28, 1
  s_cmp_lg_u32 s28, 0
  s_cbranch_scc1 L_fb_p1
  v_mov_b32 v3, v10
  s_nop 1
  v_permlane32_swap_b32 v10, v3
  s_nop 1
  v_max_f32 v10, v10, v3
  v_sub_f32 v128, 0, v10
  v_sub_f32 v129, 0, v10
  v_sub_f32 v130, 0, v10
  v_sub_f32 v131, 0, v10
  v_sub_f32 v132, 0, v10
  v_sub_f32 v133, 0, v10
  v_sub_f32 v134, 0, v10
  v_sub_f32 v135, 0, v10
  v_sub_f32 v136, 0, v10
  v_sub_f32 v137, 0, v10
  v_sub_f32 v138, 0, v10
  v_sub_f32 v139, 0, v10
  v_sub_f32 v140, 0, v10
  v_sub_f32 v141, 0, v10
  v_sub_f32 v142, 0, v10
  v_sub_f32 v143, 0, v10
  v_mov_b32 v96, 0
  v_mov_b32 v97, 0
  v_mov_b32 v98, 0
  v_mov_b32 v99, 0
  v_mov_b32 v100, 0
  v_mov_b32 v101, 0
  v_mov_b32 v102, 0
  v_mov_b32 v103, 0
  v_mov_b32 v104, 0
  v_mov_b32 v105, 0
  v_mov_b32 v106, 0
  v_mov_b32 v107, 0
  v_mov_b32 v108, 0
  v_mov_b32 v109, 0
  v_mov_b32 v110, 0
  v_mov_b32 v111, 0
  s_mov_b32 s20, s29
  s_mov_b32 s28, 64
L_fb_p2:
  buffer_load_dwordx2 v[28:29], v252, s[4:7], s20 offen
  buffer_load_dwordx2 v[30:31], v252, s[4:7], s20 offen offset:512
  buffer_load_dwordx2 v[32:33], v14, s[4:7], s20 offen
  s_mov_b64 exec, s[24:25]
  buffer_load_dwordx4 v[36:39], v15, s[4:7], s20 offen
  buffer_load_dwordx4 v[40:43], v2, s[4:7], s20 offen
  s_mov_b64 exec, -1
  s_waitcnt vmcnt(0)
  v_mfma_f32_32x32x16_bf16 v[64:79], v[28:31], v[16:19], v[128:143]
  v_mfma_f32_32x32x8bf16_1k v[64:79], v[32:33], v[22:23], v[64:79]
  s_nop 15
  v_exp_f32 v64, v64
  v_exp_f32 v65, v65
  v_exp_f32 v66, v66
  v_exp_f32 v67, v67
  v_exp_f32 v68, v68
  v_exp_f32 v69, v69
  v_exp_f32 v70, v70
  v_exp_f32 v71, v71
  v_exp_f32 v72, v72
  v_exp_f32 v73, v73
  v_exp_f32 v74, v74
  v_exp_f32 v75, v75
  v_exp_f32 v76, v76
  v_exp_f32 v77, v77
  v_exp_f32 v78, v78
  v_exp_f32 v79, v79
  s_nop 0
  v_cvt_pk_bf16_f32 v52, v64, v65
  v_cvt_pk_bf16_f32 v53, v66, v67
  v_cvt_pk_bf16_f32 v54, v68, v69
  v_cvt_pk_bf16_f32 v55, v70, v71
  v_cvt_pk_bf16_f32 v56, v72, v73
  v_cvt_pk_bf16_f32 v57, v74, v75
  v_cvt_pk_bf16_f32 v58, v76, v77
  v_cvt_pk_bf16_f32 v59, v78, v79
  s_nop 1
  v_mfma_f32_32x32x16_bf16 v[96:111], v[36:39], v[52:55], v[96:111]
  v_mfma_f32_32x32x16_bf16 v[96:111], v[40:43], v[56:59], v[96:111]
  s_add_u32 s20, s20, 2560
  s_sub_u32 s28, s28, 1
  s_cmp_lg_u32 s28, 0
  s_cbranch_scc1 L_fb_p2
  s_nop 15
  v_mov_b32 v3, v104
  v_mov_b32 v4, v104
  s_nop 1
  v_permlane32_swap_b32 v3, v4
  s_nop 1
  s_branch L_b_store
L_p3:
  s_cmp_ge_u32 s97, 4
  s_cbranch_scc1 L_done
  s_load_dwordx2 s[50:51], s[0:1], 48
  s_bfe_u32 s29, s96, 0x10002
  s_and_b32 s30, s96, 3
  s_lshl_b32 s30, s30, 1
  s_lshr_b32 s20, s96, 7
  s_add_u32 s30, s30, s20
  s_lshl_b32 s30, s30, 1
  s_bfe_u32 s20, s96, 0x10006
  s_add_u32 s30, s30, s20
  s_bfe_u32 s31, s96, 0x30003
  s_and_b32 s28, s31, 3
  v_and_b32 v8, 15, v1
  v_lshrrev_b32 v9, 4, v1
  v_lshlrev_b32 v2, 4, v1
  v_lshlrev_b32 v3, 3, v1
  s_lshl_b32 s20, s30, 3
  s_lshl_b32 s21, s97, 1
  s_add_u32 s20, s20, s21
  s_lshl_b32 s32, s20, 14
  s_lshl_b32 s36, s20, 12
  s_add_u32 s36, s36, 2097152
  s_add_u32 s37, s36, 4096
  s_mul_i32 s20, s29, 2621440
  s_add_u32 s20, s20, 15728640
  s_add_u32 s52, s100, s20
  s_addc_u32 s53, s101, 0
  s_mov_b32 s4, s52
  s_and_b32 s5, s53, 0xffff
  s_mov_b32 s6, 2621440
  s_mov_b32 s7, 0x20000
  v_bfe_u32 v4, v1, 2, 2
  v_mul_u32_u24 v4, 160, v4
  v_and_b32 v5, 3, v1
  v_lshl_add_u32 v4, v5, 3, v4
  v_add_u32 v4, 40960, v4
  v_lshrrev_b32 v5, 1, v9
  v_mul_u32_u24 v5, 5, v5
  v_and_b32 v6, 1, v9
  v_add_u32 v5, v5, v6
  v_mul_u32_u24 v5, 640, v5
  v_add_u32 v10, v4, v5
  v_mul_u32_u24 v5, 3200, v9
  v_add3_u32 v14, v4, v5, 0
  v_add_u32 v14, 2560, v14
  v_mov_b32 v216, 0
  v_mov_b32 v217, 0
  v_mov_b32 v218, 0
  v_mov_b32 v219, 0
  v_mov_b32 v220, 0
  v_mov_b32 v221, 0
  v_mov_b32 v222, 0
  v_mov_b32 v223, 0
  v_mov_b32 v224, 0
  v_mov_b32 v225, 0
  v_mov_b32 v226, 0
  v_mov_b32 v227, 0
  v_mov_b32 v228, 0
  v_mov_b32 v229, 0
  v_mov_b32 v230, 0
  v_mov_b32 v231, 0
  v_mov_b32 v232, 0
  v_mov_b32 v233, 0
  v_mov_b32 v234, 0
  v_mov_b32 v235, 0
  v_mov_b32 v236, 0
  v_mov_b32 v237, 0
  v_mov_b32 v238, 0
  v_mov_b32 v239, 0
  v_mov_b32 v240, 0
  v_mov_b32 v241, 0
  v_mov_b32 v242, 0
  v_mov_b32 v243, 0
  v_mov_b32 v244, 0
  v_mov_b32 v245, 0
  v_mov_b32 v246, 0
  v_mov_b32 v247, 0
  v_mov_b32 v248, 0
  v_mov_b32 v249, 0
  v_mov_b32 v250, 0
  v_mov_b32 v251, 0
  v_mov_b32 v252, 0
  v_mov_b32 v253, 0
  v_mov_b32 v254, 0
  v_mov_b32 v255, 0
  s_lshl_b32 s20, s30, 7
  s_lshl_b32 s21, s97, 5
  s_add_u32 s20, s20, s21
  v_add_u32 v4, s20, v8
  v_mul_u32_u24 v4, 2560, v4
  v_and_b32 v5, 1, v9
  v_lshlrev_b32 v5, 5, v5
  v_lshrrev_b32 v6, 1, v9
  v_lshl_add_u32 v5, v6, 4, v5
  v_add_u32 v11, v4, v5
  v_lshl_add_u32 v7, v9, 3, v4
  s_barrier
  s_lshl_b32 s33, s31, 1
  s_add_u32 s40, s33, 0
  s_and_b32 s40, s40, 15
  s_lshl_b32 s40, s40, 10
  s_add_u32 s40, s40, s32
  s_add_u32 s41, s40, 16384
  buffer_load_dwordx4 v[16:19], v2, s[4:7], s40 offen
  buffer_load_dwordx4 v[20:23], v2, s[4:7], s41 offen
  s_add_u32 s42, s33, 1
  s_and_b32 s42, s42, 15
  s_lshl_b32 s42, s42, 10
  s_add_u32 s42, s42, s32
  s_add_u32 s43, s42, 16384
  buffer_load_dwordx4 v[24:27], v2, s[4:7], s42 offen
  buffer_load_dwordx4 v[28:31], v2, s[4:7], s43 offen
  s_add_u32 s44, s33, 2
  s_and_b32 s44, s44, 15
  s_lshl_b32 s44, s44, 10
  s_add_u32 s44, s44, s32
  s_add_u32 s45, s44, 16384
  buffer_load_dwordx4 v[32:35], v2, s[4:7], s44 offen
  buffer_load_dwordx4 v[36:39], v2, s[4:7], s45 offen
  s_add_u32 s46, s33, 3
  s_and_b32 s46, s46, 15
  s_lshl_b32 s46, s46, 10
  s_add_u32 s46, s46, s32
  s_add_u32 s47, s46, 16384
  buffer_load_dwordx4 v[40:43], v2, s[4:7], s46 offen
  buffer_load_dwordx4 v[44:47], v2, s[4:7], s47 offen
  s_add_u32 s40, s33, 4
  s_and_b32 s40, s40, 15
  s_lshl_b32 s40, s40, 10
  s_add_u32 s40, s40, s32
  s_add_u32 s41, s40, 16384
  buffer_load_dwordx4 v[48:51], v2, s[4:7], s40 offen
  buffer_load_dwordx4 v[52:55], v2, s[4:7], s41 offen
  s_add_u32 s42, s33, 5
  s_and_b32 s42, s42, 15
  s_lshl_b32 s42, s42, 10
  s_add_u32 s42, s42, s32
  s_add_u32 s43, s42, 16384
  buffer_load_dwordx4 v[56:59], v2, s[4:7], s42 offen
  buffer_load_dwordx4 v[60:63], v2, s[4:7], s43 offen
  s_waitcnt lgkmcnt(0)
  s_mov_b32 s8, s50
  s_and_b32 s9, s51, 0xffff
  s_mov_b32 s10, 5242880
  s_mov_b32 s11, 0x20000
  v_add_u32 v15, 51200, v14
  s_add_u32 s20, s33, 0
  s_and_b32 s20, s20, 15
  s_mul_i32 s20, s20, 6400
  v_add_u32 v12, s20, v10
  ds_read_b64_tr_b16 v[176:177], v12 offset:0
  ds_read_b64_tr_b16 v[178:179], v12 offset:1280
  ds_read_b64_tr_b16 v[180:181], v12 offset:32
  ds_read_b64_tr_b16 v[182:183], v12 offset:1312
  ds_read_b64_tr_b16 v[184:185], v12 offset:64
  ds_read_b64_tr_b16 v[186:187], v12 offset:1344
  ds_read_b64_tr_b16 v[188:189], v12 offset:96
  ds_read_b64_tr_b16 v[190:191], v12 offset:1376
  ds_read_b64_tr_b16 v[192:193], v12 offset:128
  ds_read_b64_tr_b16 v[194:195], v12 offset:1408
  s_add_u32 s20, s33, 1
  s_and_b32 s20, s20, 15
  s_mul_i32 s20, s20, 6400
  v_add_u32 v13, s20, v10
  s_waitcnt lgkmcnt(0) vmcnt(10)
  v_mfma_f32_16x16x32_bf16 v[216:219], v[176:179], v[16:19], v[216:219]
  ds_read_b64_tr_b16 v[196:197], v13 offset:0
  ds_read_b64_tr_b16 v[198:199], v13 offset:1280
  v_mfma_f32_16x16x32_bf16 v[220:223], v[176:179], v[20:23], v[220:223]
  ds_read_b64_tr_b16 v[200:201], v13 offset:32
  ds_read_b64_tr_b16 v[202:203], v13 offset:1312
  v_mfma_f32_16x16x32_bf16 v[224:227], v[180:183], v[16:19], v[224:227]
  ds_read_b64_tr_b16 v[204:205], v13 offset:64
  ds_read_b64_tr_b16 v[206:207], v13 offset:1344
  v_mfma_f32_16x16x32_bf16 v[228:231], v[180:183], v[20:23], v[228:231]
  ds_read_b64_tr_b16 v[208:209], v13 offset:96
  ds_read_b64_tr_b16 v[210:211], v13 offset:1376
  v_mfma_f32_16x16x32_bf16 v[232:235], v[184:187], v[16:19], v[232:235]
  ds_read_b64_tr_b16 v[212:213], v13 offset:128
  ds_read_b64_tr_b16 v[214:215], v13 offset:1408
  v_mfma_f32_16x16x32_bf16 v[236:239], v[184:187], v[20:23], v[236:239]
  s_add_u32 s44, s33, 6
  s_and_b32 s44, s44, 15
  v_mfma_f32_16x16x32_bf16 v[240:243], v[188:191], v[16:19], v[240:243]
  s_lshl_b32 s44, s44, 10
  s_add_u32 s44, s44, s32
  v_mfma_f32_16x16x32_bf16 v[244:247], v[188:191], v[20:23], v[244:247]
  s_add_u32 s45, s44, 16384
  buffer_load_dwordx4 v[64:67], v2, s[4:7], s44 offen
  v_mfma_f32_16x16x32_bf16 v[248:251], v[192:195], v[16:19], v[248:251]
  buffer_load_dwordx4 v[68:71], v2, s[4:7], s45 offen
  v_mfma_f32_16x16x32_bf16 v[252:255], v[192:195], v[20:23], v[252:255]
  s_add_u32 s20, s33, 2
  s_and_b32 s20, s20, 15
  s_mul_i32 s20, s20, 6400
  v_add_u32 v12, s20, v10
  s_waitcnt lgkmcnt(0) vmcnt(10)
  v_mfma_f32_16x16x32_bf16 v[216:219], v[196:199], v[24:27], v[216:219]
  ds_read_b64_tr_b16 v[176:177], v12 offset:0
  ds_read_b64_tr_b16 v[178:179], v12 offset:1280
  v_mfma_f32_16x16x32_bf16 v[220:223], v[196:199], v[28:31], v[220:223]
  ds_read_b64_tr_b16 v[180:181], v12 offset:32
  ds_read_b64_tr_b16 v[182:183], v12 offset:1312
  v_mfma_f32_16x16x32_bf16 v[224:227], v[200:203], v[24:27], v[224:227]
  ds_read_b64_tr_b16 v[184:185], v12 offset:64
  ds_read_b64_tr_b16 v[186:187], v12 offset:1344
  v_mfma_f32_16x16x32_bf16 v[228:231], v[200:203], v[28:31], v[228:231]
  ds_read_b64_tr_b16 v[188:189], v12 offset:96
  ds_read_b64_tr_b16 v[190:191], v12 offset:1376
  v_mfma_f32_16x16x32_bf16 v[232:235], v[204:207], v[24:27], v[232:235]
  ds_read_b64_tr_b16 v[192:193], v12 offset:128
  ds_read_b64_tr_b16 v[194:195], v12 offset:1408
  v_mfma_f32_16x16x32_bf16 v[236:239], v[204:207], v[28:31], v[236:239]
  s_add_u32 s46, s33, 7
  s_and_b32 s46, s46, 15
  v_mfma_f32_16x16x32_bf16 v[240:243], v[208:211], v[24:27], v[240:243]
  s_lshl_b32 s46, s46, 10
  s_add_u32 s46, s46, s32
  v_mfma_f32_16x16x32_bf16 v[244:247], v[208:211], v[28:31], v[244:247]
  s_add_u32 s47, s46, 16384
  buffer_load_dwordx4 v[72:75], v2, s[4:7], s46 offen
  v_mfma_f32_16x16x32_bf16 v[248:251], v[212:215], v[24:27], v[248:251]
  buffer_load_dwordx4 v[76:79], v2, s[4:7], s47 offen
  v_mfma_f32_16x16x32_bf16 v[252:255], v[212:215], v[28:31], v[252:255]
  s_add_u32 s20, s33, 3
  s_and_b32 s20, s20, 15
  s_mul_i32 s20, s20, 6400
  v_add_u32 v13, s20, v10
  s_waitcnt lgkmcnt(0) vmcnt(10)
  v_mfma_f32_16x16x32_bf16 v[216:219], v[176:179], v[32:35], v[216:219]
  ds_read_b64_tr_b16 v[196:197], v13 offset:0
  ds_read_b64_tr_b16 v[198:199], v13 offset:1280
  v_mfma_f32_16x16x32_bf16 v[220:223], v[176:179], v[36:39], v[220:223]
  ds_read_b64_tr_b16 v[200:201], v13 offset:32
  ds_read_b64_tr_b16 v[202:203], v13 offset:1312
  v_mfma_f32_16x16x32_bf16 v[224:227], v[180:183], v[32:35], v[224:227]
  ds_read_b64_tr_b16 v[204:205], v13 offset:64
  ds_read_b64_tr_b16 v[206:207], v13 offset:1344
  v_mfma_f32_16x16x32_bf16 v[228:231], v[180:183], v[36:39], v[228:231]
  ds_read_b64_tr_b16 v[208:209], v13 offset:96
  ds_read_b64_tr_b16 v[210:211], v13 offset:1376
  v_mfma_f32_16x16x32_bf16 v[232:235], v[184:187], v[32:35], v[232:235]
  ds_read_b64_tr_b16 v[212:213], v13 offset:128
  ds_read_b64_tr_b16 v[214:215], v13 offset:1408
  v_mfma_f32_16x16x32_bf16 v[236:239], v[184:187], v[36:39], v[236:239]
  s_add_u32 s40, s33, 8
  s_and_b32 s40, s40, 15
  v_mfma_f32_16x16x32_bf16 v[240:243], v[188:191], v[32:35], v[240:243]
  s_lshl_b32 s40, s40, 10
  s_add_u32 s40, s40, s32
  v_mfma_f32_16x16x32_bf16 v[244:247], v[188:191], v[36:39], v[244:247]
  s_add_u32 s41, s40, 16384
  buffer_load_dwordx4 v[80:83], v2, s[4:7], s40 offen
  v_mfma_f32_16x16x32_bf16 v[248:251], v[192:195], v[32:35], v[248:251]
  buffer_load_dwordx4 v[84:87], v2, s[4:7], s41 offen
  v_mfma_f32_16x16x32_bf16 v[252:255], v[192:195], v[36:39], v[252:255]
  s_add_u32 s20, s33, 4
  s_and_b32 s20, s20, 15
  s_mul_i32 s20, s20, 6400
  v_add_u32 v12, s20, v10
  s_waitcnt lgkmcnt(0) vmcnt(10)
  v_mfma_f32_16x16x32_bf16 v[216:219], v[196:199], v[40:43], v[216:219]
  ds_read_b64_tr_b16 v[176:177], v12 offset:0
  ds_read_b64_tr_b16 v[178:179], v12 offset:1280
  v_mfma_f32_16x16x32_bf16 v[220:223], v[196:199], v[44:47], v[220:223]
  ds_read_b64_tr_b16 v[180:181], v12 offset:32
  ds_read_b64_tr_b16 v[182:183], v12 offset:1312
  v_mfma_f32_16x16x32_bf16 v[224:227], v[200:203], v[40:43], v[224:227]
  ds_read_b64_tr_b16 v[184:185], v12 offset:64
  ds_read_b64_tr_b16 v[186:187], v12 offset:1344
  v_mfma_f32_16x16x32_bf16 v[228:231], v[200:203], v[44:47], v[228:231]
  ds_read_b64_tr_b16 v[188:189], v12 offset:96
  ds_read_b64_tr_b16 v[190:191], v12 offset:1376
  v_mfma_f32_16x16x32_bf16 v[232:235], v[204:207], v[40:43], v[232:235]
  ds_read_b64_tr_b16 v[192:193], v12 offset:128
  ds_read_b64_tr_b16 v[194:195], v12 offset:1408
  v_mfma_f32_16x16x32_bf16 v[236:239], v[204:207], v[44:47], v[236:239]
  s_add_u32 s42, s33, 9
  s_and_b32 s42, s42, 15
  v_mfma_f32_16x16x32_bf16 v[240:243], v[208:211], v[40:43], v[240:243]
  s_lshl_b32 s42, s42, 10
  s_add_u32 s42, s42, s32
  v_mfma_f32_16x16x32_bf16 v[244:247], v[208:211], v[44:47], v[244:247]
  s_add_u32 s43, s42, 16384
  buffer_load_dwordx4 v[88:91], v2, s[4:7], s42 offen
  v_mfma_f32_16x16x32_bf16 v[248:251], v[212:215], v[40:43], v[248:251]
  buffer_load_dwordx4 v[92:95], v2, s[4:7], s43 offen
  v_mfma_f32_16x16x32_bf16 v[252:255], v[212:215], v[44:47], v[252:255]
  s_add_u32 s20, s33, 5
  s_and_b32 s20, s20, 15
  s_mul_i32 s20, s20, 6400
  v_add_u32 v13, s20, v10
  s_waitcnt lgkmcnt(0) vmcnt(10)
  v_mfma_f32_16x16x32_bf16 v[216:219], v[176:179], v[48:51], v[216:219]
  ds_read_b64_tr_b16 v[196:197], v13 offset:0
  ds_read_b64_tr_b16 v[198:199], v13 offset:1280
  v_mfma_f32_16x16x32_bf16 v[220:223], v[176:179], v[52:55], v[220:223]
  ds_read_b64_tr_b16 v[200:201], v13 offset:32
  ds_read_b64_tr_b16 v[202:203], v13 offset:1312
  v_mfma_f32_16x16x32_bf16 v[224:227], v[180:183], v[48:51], v[224:227]
  ds_read_b64_tr_b16 v[204:205], v13 offset:64
  ds_read_b64_tr_b16 v[206:207], v13 offset:1344
  v_mfma_f32_16x16x32_bf16 v[228:231], v[180:183], v[52:55], v[228:231]
  ds_read_b64_tr_b16 v[208:209], v13 offset:96
  ds_read_b64_tr_b16 v[210:211], v13 offset:1376
  v_mfma_f32_16x16x32_bf16 v[232:235], v[184:187], v[48:51], v[232:235]
  ds_read_b64_tr_b16 v[212:213], v13 offset:128
  ds_read_b64_tr_b16 v[214:215], v13 offset:1408
  v_mfma_f32_16x16x32_bf16 v[236:239], v[184:187], v[52:55], v[236:239]
  s_add_u32 s44, s33, 10
  s_and_b32 s44, s44, 15
  v_mfma_f32_16x16x32_bf16 v[240:243], v[188:191], v[48:51], v[240:243]
  s_lshl_b32 s44, s44, 10
  s_add_u32 s44, s44, s32
  v_mfma_f32_16x16x32_bf16 v[244:247], v[188:191], v[52:55], v[244:247]
  s_add_u32 s45, s44, 16384
  buffer_load_dwordx4 v[96:99], v2, s[4:7], s44 offen
  v_mfma_f32_16x16x32_bf16 v[248:251], v[192:195], v[48:51], v[248:251]
  buffer_load_dwordx4 v[100:103], v2, s[4:7], s45 offen
  v_mfma_f32_16x16x32_bf16 v[252:255], v[192:195], v[52:55], v[252:255]
  s_add_u32 s20, s33, 6
  s_and_b32 s20, s20, 15
  s_mul_i32 s20, s20, 6400
  v_add_u32 v12, s20, v10
  s_waitcnt lgkmcnt(0) vmcnt(10)
  v_mfma_f32_16x16x32_bf16 v[216:219], v[196:199], v[56:59], v[216:219]
  ds_read_b64_tr_b16 v[176:177], v12 offset:0
  ds_read_b64_tr_b16 v[178:179], v12 offset:1280
  v_mfma_f32_16x16x32_bf16 v[220:223], v[196:199], v[60:63], v[220:223]
  ds_read_b64_tr_b16 v[180:181], v12 offset:32
  ds_read_b64_tr_b16 v[182:183], v12 offset:1312
  v_mfma_f32_16x16x32_bf16 v[224:227], v[200:203], v[56:59], v[224:227]
  ds_read_b64_tr_b16 v[184:185], v12 offset:64
  ds_read_b64_tr_b16 v[186:187], v12 offset:1344
  v_mfma_f32_16x16x32_bf16 v[228:231], v[200:203], v[60:63], v[228:231]
  ds_read_b64_tr_b16 v[188:189], v12 offset:96
  ds_read_b64_tr_b16 v[190:191], v12 offset:1376
  v_mfma_f32_16x16x32_bf16 v[232:235], v[204:207], v[56:59], v[232:235]
  ds_read_b64_tr_b16 v[192:193], v12 offset:128
  ds_read_b64_tr_b16 v[194:195], v12 offset:1408
  v_mfma_f32_16x16x32_bf16 v[236:239], v[204:207], v[60:63], v[236:239]
  s_add_u32 s46, s33, 11
  s_and_b32 s46, s46, 15
  v_mfma_f32_16x16x32_bf16 v[240:243], v[208:211], v[56:59], v[240:243]
  s_lshl_b32 s46, s46, 10
  s_add_u32 s46, s46, s32
  v_mfma_f32_16x16x32_bf16 v[244:247], v[208:211], v[60:63], v[244:247]
  s_add_u32 s47, s46, 16384
  buffer_load_dwordx4 v[104:107], v2, s[4:7], s46 offen
  v_mfma_f32_16x16x32_bf16 v[248:251], v[212:215], v[56:59], v[248:251]
  buffer_load_dwordx4 v[108:111], v2, s[4:7], s47 offen
  v_mfma_f32_16x16x32_bf16 v[252:255], v[212:215], v[60:63], v[252:255]
  s_add_u32 s20, s33, 7
  s_and_b32 s20, s20, 15
  s_mul_i32 s20, s20, 6400
  v_add_u32 v13, s20, v10
  s_waitcnt lgkmcnt(0) vmcnt(10)
  v_mfma_f32_16x16x32_bf16 v[216:219], v[176:179], v[64:67], v[216:219]
  ds_read_b64_tr_b16 v[196:197], v13 offset:0
  ds_read_b64_tr_b16 v[198:199], v13 offset:1280
  v_mfma_f32_16x16x32_bf16 v[220:223], v[176:179], v[68:71], v[220:223]
  ds_read_b64_tr_b16 v[200:201], v13 offset:32
  ds_read_b64_tr_b16 v[202:203], v13 offset:1312
  v_mfma_f32_16x16x32_bf16 v[224:227], v[180:183], v[64:67], v[224:227]
  ds_read_b64_tr_b16 v[204:205], v13 offset:64
  ds_read_b64_tr_b16 v[206:207], v13 offset:1344
  v_mfma_f32_16x16x32_bf16 v[228:231], v[180:183], v[68:71], v[228:231]
  ds_read_b64_tr_b16 v[208:209], v13 offset:96
  ds_read_b64_tr_b16 v[210:211], v13 offset:1376
  v_mfma_f32_16x16x32_bf16 v[232:235], v[184:187], v[64:67], v[232:235]
  ds_read_b64_tr_b16 v[212:213], v13 offset:128
  ds_read_b64_tr_b16 v[214:215], v13 offset:1408
  v_mfma_f32_16x16x32_bf16 v[236:239], v[184:187], v[68:71], v[236:239]
  s_add_u32 s40, s33, 12
  s_and_b32 s40, s40, 15
  v_mfma_f32_16x16x32_bf16 v[240:243], v[188:191], v[64:67], v[240:243]
  s_lshl_b32 s40, s40, 10
  s_add_u32 s40, s40, s32
  v_mfma_f32_16x16x32_bf16 v[244:247], v[188:191], v[68:71], v[244:247]
  s_add_u32 s41, s40, 16384
  buffer_load_dwordx4 v[112:115], v2, s[4:7], s40 offen
  v_mfma_f32_16x16x32_bf16 v[248:251], v[192:195], v[64:67], v[248:251]
  buffer_load_dwordx4 v[116:119], v2, s[4:7], s41 offen
  v_mfma_f32_16x16x32_bf16 v[252:255], v[192:195], v[68:71], v[252:255]
  s_add_u32 s20, s33, 8
  s_and_b32 s20, s20, 15
  s_mul_i32 s20, s20, 6400
  v_add_u32 v12, s20, v10
  s_waitcnt lgkmcnt(0) vmcnt(10)
  v_mfma_f32_16x16x32_bf16 v[216:219], v[196:199], v[72:75], v[216:219]
  ds_read_b64_tr_b16 v[176:177], v12 offset:0
  ds_read_b64_tr_b16 v[178:179], v12 offset:1280
  v_mfma_f32_16x16x32_bf16 v[220:223], v[196:199], v[76:79], v[220:223]
  ds_read_b64_tr_b16 v[180:181], v12 offset:32
  ds_read_b64_tr_b16 v[182:183], v12 offset:1312
  v_mfma_f32_16x16x32_bf16 v[224:227], v[200:203], v[72:75], v[224:227]
  ds_read_b64_tr_b16 v[184:185], v12 offset:64
  ds_read_b64_tr_b16 v[186:187], v12 offset:1344
  v_mfma_f32_16x16x32_bf16 v[228:231], v[200:203], v[76:79], v[228:231]
  ds_read_b64_tr_b16 v[188:189], v12 offset:96
  ds_read_b64_tr_b16 v[190:191], v12 offset:1376
  v_mfma_f32_16x16x32_bf16 v[232:235], v[204:207], v[72:75], v[232:235]
  ds_read_b64_tr_b16 v[192:193], v12 offset:128
  ds_read_b64_tr_b16 v[194:195], v12 offset:1408
  v_mfma_f32_16x16x32_bf16 v[236:239], v[204:207], v[76:79], v[236:239]
  s_add_u32 s42, s33, 13
  s_and_b32 s42, s42, 15
  v_mfma_f32_16x16x32_bf16 v[240:243], v[208:211], v[72:75], v[240:243]
  s_lshl_b32 s42, s42, 10
  s_add_u32 s42, s42, s32
  v_mfma_f32_16x16x32_bf16 v[244:247], v[208:211], v[76:79], v[244:247]
  s_add_u32 s43, s42, 16384
  buffer_load_dwordx4 v[120:123], v2, s[4:7], s42 offen
  v_mfma_f32_16x16x32_bf16 v[248:251], v[212:215], v[72:75], v[248:251]
  buffer_load_dwordx4 v[124:127], v2, s[4:7], s43 offen
  v_mfma_f32_16x16x32_bf16 v[252:255], v[212:215], v[76:79], v[252:255]
  s_add_u32 s20, s33, 9
  s_and_b32 s20, s20, 15
  s_mul_i32 s20, s20, 6400
  v_add_u32 v13, s20, v10
  s_waitcnt lgkmcnt(0) vmcnt(10)
  v_mfma_f32_16x16x32_bf16 v[216:219], v[176:179], v[80:83], v[216:219]
  ds_read_b64_tr_b16 v[196:197], v13 offset:0
  ds_read_b64_tr_b16 v[198:199], v13 offset:1280
  v_mfma_f32_16x16x32_bf16 v[220:223], v[176:179], v[84:87], v[220:223]
  ds_read_b64_tr_b16 v[200:201], v13 offset:32
  ds_read_b64_tr_b16 v[202:203], v13 offset:1312
  v_mfma_f32_16x16x32_bf16 v[224:227], v[180:183], v[80:83], v[224:227]
  ds_read_b64_tr_b16 v[204:205], v13 offset:64
  ds_read_b64_tr_b16 v[206:207], v13 offset:1344
  v_mfma_f32_16x16x32_bf16 v[228:231], v[180:183], v[84:87], v[228:231]
  ds_read_b64_tr_b16 v[208:209], v13 offset:96
  ds_read_b64_tr_b16 v[210:211], v13 offset:1376
  v_mfma_f32_16x16x32_bf16 v[232:235], v[184:187], v[80:83], v[232:235]
  ds_read_b64_tr_b16 v[212:213], v13 offset:128
  ds_read_b64_tr_b16 v[214:215], v13 offset:1408
  v_mfma_f32_16x16x32_bf16 v[236:239], v[184:187], v[84:87], v[236:239]
  s_add_u32 s44, s33, 14
  s_and_b32 s44, s44, 15
  v_mfma_f32_16x16x32_bf16 v[240:243], v[188:191], v[80:83], v[240:243]
  s_lshl_b32 s44, s44, 10
  s_add_u32 s44, s44, s32
  v_mfma_f32_16x16x32_bf16 v[244:247], v[188:191], v[84:87], v[244:247]
  s_add_u32 s45, s44, 16384
  buffer_load_dwordx4 v[128:131], v2, s[4:7], s44 offen
  v_mfma_f32_16x16x32_bf16 v[248:251], v[192:195], v[80:83], v[248:251]
  buffer_load_dwordx4 v[132:135], v2, s[4:7], s45 offen
  v_mfma_f32_16x16x32_bf16 v[252:255], v[192:195], v[84:87], v[252:255]
  s_add_u32 s20, s33, 10
  s_and_b32 s20, s20, 15
  s_mul_i32 s20, s20, 6400
  v_add_u32 v12, s20, v10
  s_waitcnt lgkmcnt(0) vmcnt(10)
  v_mfma_f32_16x16x32_bf16 v[216:219], v[196:199], v[88:91], v[216:219]
  ds_read_b64_tr_b16 v[176:177], v12 offset:0
  ds_read_b64_tr_b16 v[178:179], v12 offset:1280
  v_mfma_f32_16x16x32_bf16 v[220:223], v[196:199], v[92:95], v[220:223]
  ds_read_b64_tr_b16 v[180:181], v12 offset:32
  ds_read_b64_tr_b16 v[182:183], v12 offset:1312
  v_mfma_f32_16x16x32_bf16 v[224:227], v[200:203], v[88:91], v[224:227]
  ds_read_b64_tr_b16 v[184:185], v12 offset:64
  ds_read_b64_tr_b16 v[186:187], v12 offset:1344
  v_mfma_f32_16x16x32_bf16 v[228:231], v[200:203], v[92:95], v[228:231]
  ds_read_b64_tr_b16 v[188:189], v12 offset:96
  ds_read_b64_tr_b16 v[190:191], v12 offset:1376
  v_mfma_f32_16x16x32_bf16 v[232:235], v[204:207], v[88:91], v[232:235]
  ds_read_b64_tr_b16 v[192:193], v12 offset:128
  ds_read_b64_tr_b16 v[194:195], v12 offset:1408
  v_mfma_f32_16x16x32_bf16 v[236:239], v[204:207], v[92:95], v[236:239]
  s_add_u32 s46, s33, 15
  s_and_b32 s46, s46, 15
  v_mfma_f32_16x16x32_bf16 v[240:243], v[208:211], v[88:91], v[240:243]
  s_lshl_b32 s46, s46, 10
  s_add_u32 s46, s46, s32
  v_mfma_f32_16x16x32_bf16 v[244:247], v[208:211], v[92:95], v[244:247]
  s_add_u32 s47, s46, 16384
  buffer_load_dwordx4 v[136:139], v2, s[4:7], s46 offen
  v_mfma_f32_16x16x32_bf16 v[248:251], v[212:215], v[88:91], v[248:251]
  buffer_load_dwordx4 v[140:143], v2, s[4:7], s47 offen
  v_mfma_f32_16x16x32_bf16 v[252:255], v[212:215], v[92:95], v[252:255]
  s_add_u32 s20, s33, 11
  s_and_b32 s20, s20, 15
  s_mul_i32 s20, s20, 6400
  v_add_u32 v13, s20, v10
  s_waitcnt lgkmcnt(0) vmcnt(10)
  v_mfma_f32_16x16x32_bf16 v[216:219], v[176:179], v[96:99], v[216:219]
  ds_read_b64_tr_b16 v[196:197], v13 offset:0
  ds_read_b64_tr_b16 v[198:199], v13 offset:1280
  v_mfma_f32_16x16x32_bf16 v[220:223], v[176:179], v[100:103], v[220:223]
  ds_read_b64_tr_b16 v[200:201], v13 offset:32
  ds_read_b64_tr_b16 v[202:203], v13 offset:1312
  v_mfma_f32_16x16x32_bf16 v[224:227], v[180:183], v[96:99], v[224:227]
  ds_read_b64_tr_b16 v[204:205], v13 offset:64
  ds_read_b64_tr_b16 v[206:207], v13 offset:1344
  v_mfma_f32_16x16x32_bf16 v[228:231], v[180:183], v[100:103], v[228:231]
  ds_read_b64_tr_b16 v[208:209], v13 offset:96
  ds_read_b64_tr_b16 v[210:211], v13 offset:1376
  v_mfma_f32_16x16x32_bf16 v[232:235], v[184:187], v[96:99], v[232:235]
  ds_read_b64_tr_b16 v[212:213], v13 offset:128
  ds_read_b64_tr_b16 v[214:215], v13 offset:1408
  v_mfma_f32_16x16x32_bf16 v[236:239], v[184:187], v[100:103], v[236:239]
  buffer_load_dwordx2 v[144:145], v3, s[4:7], s36 offen offset:0
  buffer_load_dwordx2 v[146:147], v3, s[4:7], s36 offen offset:512
  v_mfma_f32_16x16x32_bf16 v[240:243], v[188:191], v[96:99], v[240:243]
  buffer_load_dwordx2 v[148:149], v3, s[4:7], s37 offen offset:0
  buffer_load_dwordx2 v[150:151], v3, s[4:7], s37 offen offset:512
  v_mfma_f32_16x16x32_bf16 v[244:247], v[188:191], v[100:103], v[244:247]
  v_mfma_f32_16x16x32_bf16 v[248:251], v[192:195], v[96:99], v[248:251]
  v_mfma_f32_16x16x32_bf16 v[252:255], v[192:195], v[100:103], v[252:255]
  s_add_u32 s20, s33, 12
  s_and_b32 s20, s20, 15
  s_mul_i32 s20, s20, 6400
  v_add_u32 v12, s20, v10
  s_waitcnt lgkmcnt(0) vmcnt(12)
  v_mfma_f32_16x16x32_bf16 v[216:219], v[196:199], v[104:107], v[216:219]
  ds_read_b64_tr_b16 v[176:177], v12 offset:0
  ds_read_b64_tr_b16 v[178:179], v12 offset:1280
  v_mfma_f32_16x16x32_bf16 v[220:223], v[196:199], v[108:111], v[220:223]
  ds_read_b64_tr_b16 v[180:181], v12 offset:32
  ds_read_b64_tr_b16 v[182:183], v12 offset:1312
  v_mfma_f32_16x16x32_bf16 v[224:227], v[200:203], v[104:107], v[224:227]
  ds_read_b64_tr_b16 v[184:185], v12 offset:64
  ds_read_b64_tr_b16 v[186:187], v12 offset:1344
  v_mfma_f32_16x16x32_bf16 v[228:231], v[200:203], v[108:111], v[228:231]
  ds_read_b64_tr_b16 v[188:189], v12 offset:96
  ds_read_b64_tr_b16 v[190:191], v12 offset:1376
  v_mfma_f32_16x16x32_bf16 v[232:235], v[204:207], v[104:107], v[232:235]
  ds_read_b64_tr_b16 v[192:193], v12 offset:128
  ds_read_b64_tr_b16 v[194:195], v12 offset:1408
  v_mfma_f32_16x16x32_bf16 v[236:239], v[204:207], v[108:111], v[236:239]
  buffer_load_dwordx2 v[152:153], v3, s[4:7], s36 offen offset:1024
  buffer_load_dwordx2 v[154:155], v3, s[4:7], s36 offen offset:1536
  v_mfma_f32_16x16x32_bf16 v[240:243], v[208:211], v[104:107], v[240:243]
  buffer_load_dwordx2 v[156:157], v3, s[4:7], s37 offen offset:1024
  buffer_load_dwordx2 v[158:159], v3, s[4:7], s37 offen offset:1536
  v_mfma_f32_16x16x32_bf16 v[244:247], v[208:211], v[108:111], v[244:247]
  v_mfma_f32_16x16x32_bf16 v[248:251], v[212:215], v[104:107], v[248:251]
  v_mfma_f32_16x16x32_bf16 v[252:255], v[212:215], v[108:111], v[252:255]
  s_add_u32 s20, s33, 13
  s_and_b32 s20, s20, 15
  s_mul_i32 s20, s20, 6400
  v_add_u32 v13, s20, v10
  s_waitcnt lgkmcnt(0) vmcnt(14)
  v_mfma_f32_16x16x32_bf16 v[216:219], v[176:179], v[112:115], v[216:219]
  ds_read_b64_tr_b16 v[196:197], v13 offset:0
  ds_read_b64_tr_b16 v[198:199], v13 offset:1280
  v_mfma_f32_16x16x32_bf16 v[220:223], v[176:179], v[116:119], v[220:223]
  ds_read_b64_tr_b16 v[200:201], v13 offset:32
  ds_read_b64_tr_b16 v[202:203], v13 offset:1312
  v_mfma_f32_16x16x32_bf16 v[224:227], v[180:183], v[112:115], v[224:227]
  ds_read_b64_tr_b16 v[204:205], v13 offset:64
  ds_read_b64_tr_b16 v[206:207], v13 offset:1344
  v_mfma_f32_16x16x32_bf16 v[228:231], v[180:183], v[116:119], v[228:231]
  ds_read_b64_tr_b16 v[208:209], v13 offset:96
  ds_read_b64_tr_b16 v[210:211], v13 offset:1376
  v_mfma_f32_16x16x32_bf16 v[232:235], v[184:187], v[112:115], v[232:235]
  ds_read_b64_tr_b16 v[212:213], v13 offset:128
  ds_read_b64_tr_b16 v[214:215], v13 offset:1408
  v_mfma_f32_16x16x32_bf16 v[236:239], v[184:187], v[116:119], v[236:239]
  buffer_load_dwordx2 v[160:161], v3, s[4:7], s36 offen offset:2048
  buffer_load_dwordx2 v[162:163], v3, s[4:7], s36 offen offset:2560
  v_mfma_f32_16x16x32_bf16 v[240:243], v[188:191], v[112:115], v[240:243]
  buffer_load_dwordx2 v[164:165], v3, s[4:7], s37 offen offset:2048
  buffer_load_dwordx2 v[166:167], v3, s[4:7], s37 offen offset:2560
  v_mfma_f32_16x16x32_bf16 v[244:247], v[188:191], v[116:119], v[244:247]
  v_mfma_f32_16x16x32_bf16 v[248:251], v[192:195], v[112:115], v[248:251]
  v_mfma_f32_16x16x32_bf16 v[252:255], v[192:195], v[116:119], v[252:255]
  s_add_u32 s20, s33, 14
  s_and_b32 s20, s20, 15
  s_mul_i32 s20, s20, 6400
  v_add_u32 v12, s20, v10
  s_waitcnt lgkmcnt(0) vmcnt(16)
  v_mfma_f32_16x16x32_bf16 v[216:219], v[196:199], v[120:123], v[216:219]
  ds_read_b64_tr_b16 v[176:177], v12 offset:0
  ds_read_b64_tr_b16 v[178:179], v12 offset:1280
  v_mfma_f32_16x16x32_bf16 v[220:223], v[196:199], v[124:127], v[220:223]
  ds_read_b64_tr_b16 v[180:181], v12 offset:32
  ds_read_b64_tr_b16 v[182:183], v12 offset:1312
  v_mfma_f32_16x16x32_bf16 v[224:227], v[200:203], v[120:123], v[224:227]
  ds_read_b64_tr_b16 v[184:185], v12 offset:64
  ds_read_b64_tr_b16 v[186:187], v12 offset:1344
  v_mfma_f32_16x16x32_bf16 v[228:231], v[200:203], v[124:127], v[228:231]
  ds_read_b64_tr_b16 v[188:189], v12 offset:96
  ds_read_b64_tr_b16 v[190:191], v12 offset:1376
  v_mfma_f32_16x16x32_bf16 v[232:235], v[204:207], v[120:123], v[232:235]
  ds_read_b64_tr_b16 v[192:193], v12 offset:128
  ds_read_b64_tr_b16 v[194:195], v12 offset:1408
  v_mfma_f32_16x16x32_bf16 v[236:239], v[204:207], v[124:127], v[236:239]
  buffer_load_dwordx2 v[168:169], v3, s[4:7], s36 offen offset:3072
  buffer_load_dwordx2 v[170:171], v3, s[4:7], s36 offen offset:3584
  v_mfma_f32_16x16x32_bf16 v[240:243], v[208:211], v[120:123], v[240:243]
  buffer_load_dwordx2 v[172:173], v3, s[4:7], s37 offen offset:3072
  buffer_load_dwordx2 v[174:175], v3, s[4:7], s37 offen offset:3584
  v_mfma_f32_16x16x32_bf16 v[244:247], v[208:211], v[124:127], v[244:247]
  v_mfma_f32_16x16x32_bf16 v[248:251], v[212:215], v[120:123], v[248:251]
  v_mfma_f32_16x16x32_bf16 v[252:255], v[212:215], v[124:127], v[252:255]
  s_add_u32 s20, s33, 15
  s_and_b32 s20, s20, 15
  s_mul_i32 s20, s20, 6400
  v_add_u32 v13, s20, v10
  s_waitcnt lgkmcnt(0) vmcnt(18)
  v_mfma_f32_16x16x32_bf16 v[216:219], v[176:179], v[128:131], v[216:219]
  ds_read_b64_tr_b16 v[196:197], v13 offset:0
  ds_read_b64_tr_b16 v[198:199], v13 offset:1280
  v_mfma_f32_16x16x32_bf16 v[220:223], v[176:179], v[132:135], v[220:223]
  ds_read_b64_tr_b16 v[200:201], v13 offset:32
  ds_read_b64_tr_b16 v[202:203], v13 offset:1312
  v_mfma_f32_16x16x32_bf16 v[224:227], v[180:183], v[128:131], v[224:227]
  ds_read_b64_tr_b16 v[204:205], v13 offset:64
  ds_read_b64_tr_b16 v[206:207], v13 offset:1344
  v_mfma_f32_16x16x32_bf16 v[228:231], v[180:183], v[132:135], v[228:231]
  ds_read_b64_tr_b16 v[208:209], v13 offset:96
  ds_read_b64_tr_b16 v[210:211], v13 offset:1376
  v_mfma_f32_16x16x32_bf16 v[232:235], v[184:187], v[128:131], v[232:235]
  ds_read_b64_tr_b16 v[212:213], v13 offset:128
  ds_read_b64_tr_b16 v[214:215], v13 offset:1408
  v_mfma_f32_16x16x32_bf16 v[236:239], v[184:187], v[132:135], v[236:239]
  v_mfma_f32_16x16x32_bf16 v[240:243], v[188:191], v[128:131], v[240:243]
  v_mfma_f32_16x16x32_bf16 v[244:247], v[188:191], v[132:135], v[244:247]
  v_mfma_f32_16x16x32_bf16 v[248:251], v[192:195], v[128:131], v[248:251]
  v_mfma_f32_16x16x32_bf16 v[252:255], v[192:195], v[132:135], v[252:255]
  s_waitcnt lgkmcnt(0) vmcnt(16)
  v_mfma_f32_16x16x32_bf16 v[216:219], v[196:199], v[136:139], v[216:219]
  ds_read_b64_tr_b16 v[176:177], v14 offset:0
  ds_read_b64_tr_b16 v[178:179], v14 offset:12800
  v_mfma_f32_16x16x32_bf16 v[220:223], v[196:199], v[140:143], v[220:223]
  ds_read_b64_tr_b16 v[180:181], v14 offset:32
  ds_read_b64_tr_b16 v[182:183], v14 offset:12832
  v_mfma_f32_16x16x32_bf16 v[224:227], v[200:203], v[136:139], v[224:227]
  ds_read_b64_tr_b16 v[184:185], v14 offset:64
  ds_read_b64_tr_b16 v[186:187], v14 offset:12864
  v_mfma_f32_16x16x32_bf16 v[228:231], v[200:203], v[140:143], v[228:231]
  ds_read_b64_tr_b16 v[188:189], v14 offset:96
  ds_read_b64_tr_b16 v[190:191], v14 offset:12896
  v_mfma_f32_16x16x32_bf16 v[232:235], v[204:207], v[136:139], v[232:235]
  ds_read_b64_tr_b16 v[192:193], v14 offset:128
  ds_read_b64_tr_b16 v[194:195], v14 offset:12928
  v_mfma_f32_16x16x32_bf16 v[236:239], v[204:207], v[140:143], v[236:239]
  v_mfma_f32_16x16x32_bf16 v[240:243], v[208:211], v[136:139], v[240:243]
  v_mfma_f32_16x16x32_bf16 v[244:247], v[208:211], v[140:143], v[244:247]
  v_mfma_f32_16x16x32_bf16 v[248:251], v[212:215], v[136:139], v[248:251]
  v_mfma_f32_16x16x32_bf16 v[252:255], v[212:215], v[140:143], v[252:255]
  s_waitcnt lgkmcnt(0) vmcnt(12)
  v_mfma_f32_16x16x32_bf16 v[216:219], v[176:179], v[144:147], v[216:219]
  ds_read_b64_tr_b16 v[196:197], v14 offset:25600
  ds_read_b64_tr_b16 v[198:199], v14 offset:38400
  v_mfma_f32_16x16x32_bf16 v[220:223], v[176:179], v[148:151], v[220:223]
  ds_read_b64_tr_b16 v[200:201], v14 offset:25632
  ds_read_b64_tr_b16 v[202:203], v14 offset:38432
  v_mfma_f32_16x16x32_bf16 v[224:227], v[180:183], v[144:147], v[224:227]
  ds_read_b64_tr_b16 v[204:205], v14 offset:25664
  ds_read_b64_tr_b16 v[206:207], v14 offset:38464
  v_mfma_f32_16x16x32_bf16 v[228:231], v[180:183], v[148:151], v[228:231]
  ds_read_b64_tr_b16 v[208:209], v14 offset:25696
  ds_read_b64_tr_b16 v[210:211], v14 offset:38496
  v_mfma_f32_16x16x32_bf16 v[232:235], v[184:187], v[144:147], v[232:235]
  ds_read_b64_tr_b16 v[212:213], v14 offset:25728
  ds_read_b64_tr_b16 v[214:215], v14 offset:38528
  v_mfma_f32_16x16x32_bf16 v[236:239], v[184:187], v[148:151], v[236:239]
  v_mfma_f32_16x16x32_bf16 v[240:243], v[188:191], v[144:147], v[240:243]
  v_mfma_f32_16x16x32_bf16 v[244:247], v[188:191], v[148:151], v[244:247]
  v_mfma_f32_16x16x32_bf16 v[248:251], v[192:195], v[144:147], v[248:251]
  v_mfma_f32_16x16x32_bf16 v[252:255], v[192:195], v[148:151], v[252:255]
  s_waitcnt lgkmcnt(0) vmcnt(8)
  v_mfma_f32_16x16x32_bf16 v[216:219], v[196:199], v[152:155], v[216:219]
  ds_read_b64_tr_b16 v[176:177], v14 offset:51200
  ds_read_b64_tr_b16 v[178:179], v14 offset:64000
  v_mfma_f32_16x16x32_bf16 v[220:223], v[196:199], v[156:159], v[220:223]
  ds_read_b64_tr_b16 v[180:181], v14 offset:51232
  ds_read_b64_tr_b16 v[182:183], v14 offset:64032
  v_mfma_f32_16x16x32_bf16 v[224:227], v[200:203], v[152:155], v[224:227]
  ds_read_b64_tr_b16 v[184:185], v14 offset:51264
  ds_read_b64_tr_b16 v[186:187], v14 offset:64064
  v_mfma_f32_16x16x32_bf16 v[228:231], v[200:203], v[156:159], v[228:231]
  ds_read_b64_tr_b16 v[188:189], v14 offset:51296
  ds_read_b64_tr_b16 v[190:191], v14 offset:64096
  v_mfma_f32_16x16x32_bf16 v[232:235], v[204:207], v[152:155], v[232:235]
  ds_read_b64_tr_b16 v[192:193], v14 offset:51328
  ds_read_b64_tr_b16 v[194:195], v14 offset:64128
  v_mfma_f32_16x16x32_bf16 v[236:239], v[204:207], v[156:159], v[236:239]
  v_mfma_f32_16x16x32_bf16 v[240:243], v[208:211], v[152:155], v[240:243]
  v_mfma_f32_16x16x32_bf16 v[244:247], v[208:211], v[156:159], v[244:247]
  v_mfma_f32_16x16x32_bf16 v[248:251], v[212:215], v[152:155], v[248:251]
  v_mfma_f32_16x16x32_bf16 v[252:255], v[212:215], v[156:159], v[252:255]
  s_waitcnt lgkmcnt(0) vmcnt(4)
  v_mfma_f32_16x16x32_bf16 v[216:219], v[176:179], v[160:163], v[216:219]
  ds_read_b64_tr_b16 v[196:197], v15 offset:25600
  ds_read_b64_tr_b16 v[198:199], v15 offset:38400
  v_mfma_f32_16x16x32_bf16 v[220:223], v[176:179], v[164:167], v[220:223]
  ds_read_b64_tr_b16 v[200:201], v15 offset:25632
  ds_read_b64_tr_b16 v[202:203], v15 offset:38432
  v_mfma_f32_16x16x32_bf16 v[224:227], v[180:183], v[160:163], v[224:227]
  ds_read_b64_tr_b16 v[204:205], v15 offset:25664
  ds_read_b64_tr_b16 v[206:207], v15 offset:38464
  v_mfma_f32_16x16x32_bf16 v[228:231], v[180:183], v[164:167], v[228:231]
  ds_read_b64_tr_b16 v[208:209], v15 offset:25696
  ds_read_b64_tr_b16 v[210:211], v15 offset:38496
  v_mfma_f32_16x16x32_bf16 v[232:235], v[184:187], v[160:163], v[232:235]
  ds_read_b64_tr_b16 v[212:213], v15 offset:25728
  ds_read_b64_tr_b16 v[214:215], v15 offset:38528
  v_mfma_f32_16x16x32_bf16 v[236:239], v[184:187], v[164:167], v[236:239]
  v_mfma_f32_16x16x32_bf16 v[240:243], v[188:191], v[160:163], v[240:243]
  v_mfma_f32_16x16x32_bf16 v[244:247], v[188:191], v[164:167], v[244:247]
  v_mfma_f32_16x16x32_bf16 v[248:251], v[192:195], v[160:163], v[248:251]
  v_mfma_f32_16x16x32_bf16 v[252:255], v[192:195], v[164:167], v[252:255]
  s_waitcnt lgkmcnt(0) vmcnt(0)
  v_mfma_f32_16x16x32_bf16 v[216:219], v[196:199], v[168:171], v[216:219]
  v_mfma_f32_16x16x32_bf16 v[220:223], v[196:199], v[172:175], v[220:223]
  v_mfma_f32_16x16x32_bf16 v[224:227], v[200:203], v[168:171], v[224:227]
  v_mfma_f32_16x16x32_bf16 v[228:231], v[200:203], v[172:175], v[228:231]
  v_mfma_f32_16x16x32_bf16 v[232:235], v[204:207], v[168:171], v[232:235]
  v_mfma_f32_16x16x32_bf16 v[236:239], v[204:207], v[172:175], v[236:239]
  v_mfma_f32_16x16x32_bf16 v[240:243], v[208:211], v[168:171], v[240:243]
  v_mfma_f32_16x16x32_bf16 v[244:247], v[208:211], v[172:175], v[244:247]
  v_mfma_f32_16x16x32_bf16 v[248:251], v[212:215], v[168:171], v[248:251]
  v_mfma_f32_16x16x32_bf16 v[252:255], v[212:215], v[172:175], v[252:255]
  s_nop 7
  s_mul_i32 s20, s29, 1280
  s_mul_i32 s21, s31, 160
  s_add_u32 s20, s20, s21
  s_add_u32 s21, s20, 40960
  v_cvt_pk_bf16_f32 v216, v216, v217
  v_cvt_pk_bf16_f32 v217, v218, v219
  v_cvt_pk_bf16_f32 v224, v224, v225
  v_cvt_pk_bf16_f32 v225, v226, v227
  v_cvt_pk_bf16_f32 v232, v232, v233
  v_cvt_pk_bf16_f32 v233, v234, v235
  v_cvt_pk_bf16_f32 v240, v240, v241
  v_cvt_pk_bf16_f32 v241, v242, v243
  v_cvt_pk_bf16_f32 v248, v248, v249
  v_cvt_pk_bf16_f32 v249, v250, v251
  v_mov_b32 v218, v224
  v_mov_b32 v219, v225
  s_nop 1
  v_permlane16_swap_b32 v216, v218
  v_permlane16_swap_b32 v217, v219
  s_nop 1
  buffer_store_dwordx4 v[216:219], v11, s[8:11], s20 offen offset:0
  v_mov_b32 v234, v240
  v_mov_b32 v235, v241
  s_nop 1
  v_permlane16_swap_b32 v232, v234
  v_permlane16_swap_b32 v233, v235
  s_nop 1
  buffer_store_dwordx4 v[232:235], v11, s[8:11], s20 offen offset:64
  buffer_store_dwordx2 v[248:249], v7, s[8:11], s20 offen offset:128
  v_cvt_pk_bf16_f32 v220, v220, v221
  v_cvt_pk_bf16_f32 v221, v222, v223
  v_cvt_pk_bf16_f32 v228, v228, v229
  v_cvt_pk_bf16_f32 v229, v230, v231
  v_cvt_pk_bf16_f32 v236, v236, v237
  v_cvt_pk_bf16_f32 v237, v238, v239
  v_cvt_pk_bf16_f32 v244, v244, v245
  v_cvt_pk_bf16_f32 v245, v246, v247
  v_cvt_pk_bf16_f32 v252, v252, v253
  v_cvt_pk_bf16_f32 v253, v254, v255
  v_mov_b32 v222, v228
  v_mov_b32 v223, v229
  s_nop 1
  v_permlane16_swap_b32 v220, v222
  v_permlane16_swap_b32 v221, v223
  s_nop 1
  buffer_store_dwordx4 v[220:223], v11, s[8:11], s21 offen offset:0
  v_mov_b32 v238, v244
  v_mov_b32 v239, v245
  s_nop 1
  v_permlane16_swap_b32 v236, v238
  v_permlane16_swap_b32 v237, v239
  s_nop 1
  buffer_store_dwordx4 v[236:239], v11, s[8:11], s21 offen offset:64
  buffer_store_dwordx2 v[252:253], v7, s[8:11], s21 offen offset:128
L_done:
  s_endpgm
L_exit:
  s_endpgm
L_code_end:
.set CODE_BYTES, (L_code_end - L_pc) & 0xfffffff0
.section .rodata,"a"
.p2align 6
.amdhsa_kernel concat_heads__sliding_block__mha_block__prompt_kernel
  .amdhsa_next_free_vgpr 256
  .amdhsa_next_free_sgpr 102
  .amdhsa_accum_offset 256
  .amdhsa_group_segment_fixed_size 0
  .amdhsa_kernarg_size 72
  .amdhsa_user_sgpr_count 2
  .amdhsa_user_sgpr_kernarg_segment_ptr 1
  .amdhsa_system_sgpr_workgroup_id_x 1
.end_amdhsa_kernel
```
